```python
import torch

def _softmax(x, axis=-1):
    return torch.softmax(x, dim=axis)
def _gelu(x):
    return torch.nn.functional.gelu(x, approximate="tanh")
def _silu(x):
    return torch.nn.functional.silu(x)
def _sigmoid(x):
    return torch.sigmoid(x)
def _layernorm(x, axis=-1, eps=1e-5):
    m = x.mean(dim=axis, keepdim=True)
    v = x.var(dim=axis, keepdim=True, unbiased=False)
    return (x - m) / torch.sqrt(v + eps)
def _scatter_add(tgt, idx, src, axis=0):
    return tgt.clone().index_add_(axis, idx, src)
def _segment_sum(src, seg, n):
    out = torch.zeros((n,) + src.shape[1:], dtype=src.dtype)
    return out.index_add_(0, seg, src)
def _pad(x, pw):
    flat = tuple(v for pair in reversed(pw) for v in pair)
    return torch.nn.functional.pad(x, flat)

kernel_name = 'gated_mix__grouped_kv_mqa__dense_activation_gelu__prompt'

def setup_inputs():

    _w = (lambda a: (lambda t: t.to(torch.bfloat16) if t.is_floating_point() else t)(torch.as_tensor(a)))
    def _A_setup():
        B, S, D, H = 1, 2048, 448, 16
        Dh = D // H
        return {
            "x": _w((lambda *s: torch.randn(*s, dtype=torch.bfloat16) * 0.05)(B, S, D)),
            "wq": _w((lambda *s: torch.randn(*s, dtype=torch.bfloat16) * 1.6)(D, H * Dh)),
            "wk": _w((lambda *s: torch.randn(*s, dtype=torch.bfloat16) * 1.6)(D, Dh)),
            "wv": _w((lambda *s: torch.randn(*s, dtype=torch.bfloat16) * 0.05)(D, Dh)),
            "wo": _w((lambda *s: torch.randn(*s, dtype=torch.bfloat16) * 0.05)(H * Dh, D)),
        }
    _A_in = _A_setup()

    def _B_setup():
        B, S, D, F = 1, 2048, 448, 1792
        return {
            "x": _w((lambda *s: torch.randn(*s, dtype=torch.bfloat16) * 0.05)(B, S, D)),
            "w1": _w((lambda *s: torch.randn(*s, dtype=torch.bfloat16) * 3.2)(D, F) * (D ** -0.5)),
            "b1": _w((lambda *s: torch.randn(*s, dtype=torch.bfloat16) * 3.2)(F) * 0.01),
            "w2": _w((lambda *s: torch.randn(*s, dtype=torch.bfloat16) * 0.4)(F, D) * (F ** -0.5)),
            "b2": _w((lambda *s: torch.randn(*s, dtype=torch.bfloat16) * 0.8)(D) * 0.01),
        }
    _B_in = _B_setup()

    return {
        "A_x": _A_in["x"],
        "A_wq": _A_in["wq"],
        "A_wk": _A_in["wk"],
        "A_wv": _A_in["wv"],
        "A_wo": _A_in["wo"],
        "B_x": _B_in["x"],
        "B_w1": _B_in["w1"],
        "B_b1": _B_in["b1"],
        "B_w2": _B_in["w2"],
        "B_b2": _B_in["b2"],
        "gate_w": _w((lambda *s: torch.randn(*s, dtype=torch.bfloat16) * 0.05)(448) * 16.0),
    }

def reference(A_x, A_wq, A_wk, A_wv, A_wo, B_x, B_w1, B_b1, B_w2, B_b2, gate_w):
    def _A_ref(x, wq, wk, wv, wo):
        B, S, D = x.shape
        H = 16
        Dh = D // H
        q = (lambda x, *d: x.permute(*d))((x @ wq).reshape(B, S, H, Dh), 0, 2, 1, 3)
        k = x @ wk
        v = x @ wv
        scores = torch.einsum("bhqd,bkd->bhqk", q, k) * (Dh ** -0.5)
        p = _softmax(scores, axis=-1)
        o = torch.einsum("bhqk,bkd->bhqd", p, v)
        return (lambda x, *d: x.permute(*d))(o, 0, 2, 1, 3).reshape(B, S, H * Dh) @ wo

    def _B_ref(x, w1, b1, w2, b2):
        h = torch.einsum("bsd,df->bsf", x, w1) + b1
        h = _gelu(h)
        return torch.einsum("bsf,fd->bsd", h, w2) + b2

    x = A_x
    g = _sigmoid((x * gate_w).sum(-1, keepdims=True))
    a = _A_ref(x, A_wq, A_wk, A_wv, A_wo)
    b = _B_ref(x, B_w1, B_b1, B_w2, B_b2)
    return g * a + (1 - g) * b
```

```asm
; @launch grid=(256,1,1) block=(512,1,1) lds=163840
.amdgcn_target "amdgcn-amd-amdhsa--gfx950"
.text
.globl gated_mix__grouped_kv_mqa__dense_activation_gelu__prompt_kernel
.p2align 8
.type gated_mix__grouped_kv_mqa__dense_activation_gelu__prompt_kernel,@function
gated_mix__grouped_kv_mqa__dense_activation_gelu__prompt_kernel:
  s_cmp_ge_u32 s2, 256
  s_cbranch_scc1 L_exit
  s_load_dwordx2 s[16:17], s[0:1], 0
  s_load_dwordx2 s[36:37], s[0:1], 48
  s_load_dwordx2 s[24:25], s[0:1], 16
  s_load_dwordx2 s[28:29], s[0:1], 24
  s_load_dwordx2 s[40:41], s[0:1], 56
  s_load_dwordx2 s[60:61], s[0:1], 96
  s_memrealtime s[74:75]
  v_lshrrev_b32 v1, 6, v0
  s_and_b32 s82, s2, 1
  s_lshr_b32 s10, s2, 3
  v_readfirstlane_b32 s3, v1
  v_lshlrev_b32 v17, 7, v0
  s_getpc_b64 s[76:77]
  s_mov_b32 s78, CODE_BYTES-1024
  s_mov_b32 s79, 0x00020000
  v_and_b32 v1, 63, v0
  buffer_load_dword v17, v17, s[76:79], 0 offen
  s_bfe_u32 s4, s2, 0x20001
  s_lshl_b32 s4, s4, 2
  s_lshr_b32 s11, s10, 3
  s_add_u32 s4, s4, s11
  s_and_b32 s10, s10, 7
  s_lshl_b32 s5, s82, 3
  s_add_u32 s5, s5, s10
  s_mov_b32 s10, 0x65432710
  s_mov_b32 s11, 0x65432170
  s_lshl_b32 s12, s5, 2
  s_lshr_b64 s[10:11], s[10:11], s12
  s_and_b32 s6, s10, 15
  s_mov_b32 s18, 1835008
  s_mov_b32 s19, 0x00020000
  s_mov_b32 s38, 1605632
  s_mov_b32 s39, 0x00020000
  s_mov_b32 s26, 25088
  s_mov_b32 s27, 0x00020000
  s_mov_b32 s30, 25088
  s_mov_b32 s31, 0x00020000
  s_mov_b32 s42, 3584
  s_mov_b32 s43, 0x00020000
  s_mov_b32 s62, 256
  s_mov_b32 s63, 0x00020000
  v_lshrrev_b32 v112, 3, v1
  v_and_b32 v113, 7, v1
  v_lshrrev_b32 v114, 4, v1
  v_xor_b32 v115, v113, v114
  v_and_b32 v116, 1, v114
  v_lshlrev_b32 v116, 2, v116
  v_xor_b32 v116, v113, v116
  v_lshlrev_b32 v2, 4, v1
  s_cmp_eq_u32 s6, 7
  s_cbranch_scc1 L_kv
  s_mul_i32 s83, s82, 7
  s_add_u32 s83, s83, s6
  s_lshl_b32 s10, s4, 7
  s_lshl_b32 s11, s3, 4
  s_add_u32 s10, s10, s11
  v_add_u32 v117, s10, v112
  v_mul_u32_u24 v117, 896, v117
  v_lshl_add_u32 v3, v115, 4, v117
  v_xor_b32 v115, 4, v115
  v_lshl_add_u32 v4, v115, 4, v117
  v_add_u32 v4, 7168, v4
  s_lshl_b32 s11, s3, 3
  v_add_u32 v117, s11, v112
  v_mul_u32_u24 v118, 3584, v117
  v_lshl_add_u32 v118, v116, 4, v118
  s_lshl_b32 s11, s83, 8
  v_add_u32 v5, s11, v118
  s_lshl_b32 s14, s3, 11
  s_lshl_b32 s15, s3, 10
  s_add_u32 s69, s4, s6
  s_and_b32 s69, s69, 3
  s_lshl_b32 s69, s69, 1
  s_mov_b32 s81, s69
  v_lshlrev_b32 v119, 1, v1
  v_lshrrev_b32 v118, 5, v1
  v_lshl_add_u32 v119, v118, 16, v119
  s_lshl_b32 s13, s83, 8
  s_lshr_b32 s11, s3, 2
  s_lshl_b32 s11, s11, 6
  s_add_u32 s13, s13, s11
  s_waitcnt lgkmcnt(0)
  s_or_b32 s10, s2, s3
  s_cmp_lg_u32 s10, 0
  s_cbranch_scc1 notok1
  s_or_b32 s74, s74, 1
  v_mov_b32 v24, s74
  v_mov_b32 v25, s75
  v_mov_b32 v26, 0
  v_mov_b32 v27, 0
  s_mov_b64 exec, 1
  buffer_atomic_cmpswap_x2 v[24:27], v26, s[60:63], 0 offen sc1
  s_mov_b64 exec, -1
notok1:
  s_add_u32 m0, s14, 0
  s_lshl_b32 s11, s81, 7
  buffer_load_dwordx4 v3, s[16:19], s11 offen lds
  s_add_u32 m0, s14, 1024
  s_mul_i32 s12, s81, 229376
  buffer_load_dwordx4 v4, s[16:19], s11 offen lds
  s_add_u32 m0, s15, 16384
  s_add_u32 s81, s81, 1
  buffer_load_dwordx4 v5, s[36:39], s12 offen lds
  s_add_u32 m0, s15, 24448
  s_cmp_ge_u32 s81, 7
  s_cselect_b32 s81, 0, s81
  buffer_load_dwordx4 v5, s[36:39], s12 offen offset:128 lds
  buffer_load_ushort v240, v119, s[40:43], s13 offen offset:0
  buffer_load_ushort v244, v119, s[40:43], s13 offen offset:64
  buffer_load_ushort v248, v119, s[40:43], s13 offen offset:128
  s_load_dwordx2 s[20:21], s[0:1], 8
  s_load_dwordx2 s[52:53], s[0:1], 80
  s_load_dwordx2 s[64:65], s[0:1], 104
  s_load_dwordx2 s[32:33], s[0:1], 32
  s_load_dwordx2 s[44:45], s[0:1], 64
  s_load_dwordx2 s[48:49], s[0:1], 72
  s_load_dwordx2 s[56:57], s[0:1], 88
  s_mov_b32 s22, 401408
  s_mov_b32 s23, 0x00020000
  s_mov_b32 s54, 896
  s_mov_b32 s55, 0x00020000
  s_mov_b32 s66, 37748736
  s_mov_b32 s67, 0x00020000
  s_mov_b32 s34, 401408
  s_mov_b32 s35, 0x00020000
  s_mov_b32 s46, 1605632
  s_mov_b32 s47, 0x00020000
  s_mov_b32 s50, 896
  s_mov_b32 s51, 0x00020000
  s_mov_b32 s58, 1835008
  s_mov_b32 s59, 0x00020000
  s_mov_b32 s10, 0x65432710
  s_mov_b32 s11, 0x65432170
  s_lshl_b32 s12, s5, 2
  s_lshr_b64 s[10:11], s[10:11], s12
  s_and_b32 s9, s10, 15
  s_and_b32 s7, s3, 3
  s_lshr_b32 s8, s3, 2
  s_add_u32 s68, s4, 1
  s_lshl_b32 s68, s68, 21
  v_mov_b32 v15, 0
  v_lshlrev_b32 v23, 3, v1
  v_mul_u32_u24 v117, 896, v112
  v_lshl_add_u32 v117, v116, 4, v117
  s_lshl_b32 s11, s9, 7
  v_add_u32 v22, s11, v117
  v_lshrrev_b32 v117, 2, v1
  s_lshl_b32 s11, s7, 4
  v_add_u32 v117, s11, v117
  v_mul_u32_u24 v118, 896, v117
  v_and_b32 v119, 3, v1
  v_lshl_add_u32 v118, v119, 4, v118
  s_mul_i32 s12, s5, 56
  v_add_u32 v7, s12, v118
  v_and_b32 v118, 15, v1
  v_add_lshl_u32 v19, s11, v118, 1
  s_lshl_b32 s12, s3, 10
  s_add_u32 s12, s12, 65592
  v_lshl_add_u32 v14, v118, 6, s12
  v_add_u32 v14, 65536, v14
  v_mov_b32 v33, 0
  v_mov_b32 v35, 0
  v_mov_b32 v37, 0
  v_mov_b32 v39, 0
  v_and_b32 v117, 31, v1
  v_lshrrev_b32 v118, 5, v1
  v_bfe_u32 v121, v1, 2, 2
  v_lshl_add_u32 v122, v118, 3, v121
  v_and_b32 v123, 1, v114
  v_bfe_u32 v124, v1, 1, 1
  v_lshl_add_u32 v124, v123, 1, v124
  v_lshrrev_b32 v125, 1, v121
  v_and_b32 v127, 1, v1
  v_lshlrev_b32 v127, 3, v127
  v_xor_b32 v126, s8, v125
  v_lshl_add_u32 v126, v126, 2, v124
  v_lshl_add_u32 v126, v126, 4, v127
  v_lshl_add_u32 v12, v122, 7, v126
  v_lshl_add_u32 v128, v118, 2, v121
  v_lshl_add_u32 v126, v125, 2, v124
  v_lshl_add_u32 v126, v126, 4, v127
  v_lshl_add_u32 v21, v128, 7, v126
  s_lshr_b32 s11, s3, 1
  s_lshl_b32 s11, s11, 12
  v_add_u32 v21, s11, v21
  v_xor_b32 v20, 64, v21
  v_lshlrev_b32 v125, 6, v122
  v_lshl_add_u32 v125, v123, 5, v125
  v_and_b32 v126, 3, v1
  v_lshl_add_u32 v13, v126, 3, v125
  v_add_u32 v13, 131072, v13
  s_mov_b32 s70, 0xbdd2d3e8
  s_mov_b32 s71, 0xbdd2d3e8
  v_mov_b32 v30, 0xc0135761
  v_mov_b32 v31, 0xc0135761
  v_mov_b32 v29, 0xbdd2d3e8
  s_add_u32 m0, s14, 32768
  s_lshl_b32 s11, s81, 7
  buffer_load_dwordx4 v3, s[16:19], s11 offen lds
  s_add_u32 m0, s14, 33792
  s_mul_i32 s12, s81, 229376
  buffer_load_dwordx4 v4, s[16:19], s11 offen lds
  s_add_u32 m0, s15, 49152
  s_add_u32 s81, s81, 1
  buffer_load_dwordx4 v5, s[36:39], s12 offen lds
  s_add_u32 m0, s15, 57216
  s_cmp_ge_u32 s81, 7
  s_cselect_b32 s81, 0, s81
  buffer_load_dwordx4 v5, s[36:39], s12 offen offset:128 lds
  s_lshl_b32 s11, s7, 5
  v_add_u32 v117, s11, v117
  v_bfe_u32 v119, v117, 1, 3
  v_xor_b32 v119, v119, v118
  v_lshlrev_b32 v129, 7, v117
  v_xor_b32 v121, 0, v119
  v_lshl_add_u32 v8, v121, 4, v129
  v_xor_b32 v121, 2, v119
  v_lshl_add_u32 v9, v121, 4, v129
  v_xor_b32 v121, 4, v119
  v_lshl_add_u32 v10, v121, 4, v129
  v_xor_b32 v121, 6, v119
  v_lshl_add_u32 v11, v121, 4, v129
  v_mov_b32 v45, 0
  v_mov_b32 v46, 0
  v_mov_b32 v47, 0
  v_mov_b32 v241, 0
  v_mov_b32 v242, 0
  v_mov_b32 v243, 0
  v_mov_b32 v245, 0
  v_mov_b32 v246, 0
  v_mov_b32 v247, 0
  v_mov_b32 v249, 0
  v_mov_b32 v250, 0
  v_mov_b32 v251, 0
  v_mov_b32 v44, 0x3f80
  s_waitcnt lgkmcnt(0)
  s_mul_i32 s12, s7, 112
  s_lshl_b32 s11, s83, 3
  s_add_u32 s12, s12, s11
  s_lshl_b32 s12, s12, 10
  s_add_u32 s76, s12, s68
  s_add_u32 s77, s76, 4096
  s_lshl_b32 s78, s83, 3
  s_add_u32 s78, s78, s68
  s_add_u32 s78, s78, 655360
  s_mov_b32 s13, 262144
  s_cmp_eq_u32 s3, 7
  s_cselect_b32 s13, s13, 0x7f000000
  s_lshl_b32 s85, s7, 13
  s_cmp_lt_u32 s3, 4
  s_cbranch_scc0 L_ffn_B
  v_add_u32 v18, 16384, v12
  s_waitcnt vmcnt(4)
  s_barrier
  ds_read_b128 v[48:51], v8 offset:0
  ds_read_b64_tr_b16 v[208:209], v18 offset:0
  ds_read_b64_tr_b16 v[210:211], v18 offset:512
  ds_read_b128 v[52:55], v9 offset:0
  ds_read_b64_tr_b16 v[212:213], v18 offset:2048
  ds_read_b64_tr_b16 v[214:215], v18 offset:2560
  ds_read_b128 v[56:59], v10 offset:0
  ds_read_b64_tr_b16 v[216:217], v18 offset:4096
  ds_read_b64_tr_b16 v[218:219], v18 offset:4608
  ds_read_b128 v[60:63], v11 offset:0
  ds_read_b64_tr_b16 v[220:221], v18 offset:6144
  ds_read_b64_tr_b16 v[222:223], v18 offset:6656
  v_mfma_f32_32x32x16_bf16 v[160:175], v[240:243], v[44:47], 0
  s_add_u32 m0, s14, 65536
  s_lshl_b32 s11, s81, 7
  buffer_load_dwordx4 v3, s[16:19], s11 offen lds
  s_add_u32 m0, s14, 66560
  s_mul_i32 s12, s81, 229376
  buffer_load_dwordx4 v4, s[16:19], s11 offen lds
  s_add_u32 m0, s15, 81920
  s_add_u32 s81, s81, 1
  buffer_load_dwordx4 v5, s[36:39], s12 offen lds
  s_add_u32 m0, s15, 89984
  s_cmp_ge_u32 s81, 7
  s_cselect_b32 s81, 0, s81
  buffer_load_dwordx4 v5, s[36:39], s12 offen offset:128 lds
  v_add_u32 v18, 49152, v12
  s_waitcnt vmcnt(4)
  s_waitcnt lgkmcnt(0)
  s_barrier
  v_mfma_f32_32x32x16_bf16 v[160:175], v[208:211], v[48:51], v[160:175]
  ds_read_b128 v[64:67], v8 offset:32768
  ds_read_b64_tr_b16 v[224:225], v18 offset:0
  ds_read_b64_tr_b16 v[226:227], v18 offset:512
  v_mfma_f32_32x32x16_bf16 v[160:175], v[212:215], v[52:55], v[160:175]
  ds_read_b128 v[68:71], v9 offset:32768
  ds_read_b64_tr_b16 v[228:229], v18 offset:2048
  ds_read_b64_tr_b16 v[230:231], v18 offset:2560
  v_mfma_f32_32x32x16_bf16 v[160:175], v[216:219], v[56:59], v[160:175]
  ds_read_b128 v[72:75], v10 offset:32768
  ds_read_b64_tr_b16 v[232:233], v18 offset:4096
  ds_read_b64_tr_b16 v[234:235], v18 offset:4608
  v_mfma_f32_32x32x16_bf16 v[160:175], v[220:223], v[60:63], v[160:175]
  ds_read_b128 v[76:79], v11 offset:32768
  ds_read_b64_tr_b16 v[236:237], v18 offset:6144
  ds_read_b64_tr_b16 v[238:239], v18 offset:6656
  s_add_u32 m0, s14, 98304
  s_lshl_b32 s11, s81, 7
  buffer_load_dwordx4 v3, s[16:19], s11 offen lds
  s_add_u32 m0, s14, 99328
  s_mul_i32 s12, s81, 229376
  buffer_load_dwordx4 v4, s[16:19], s11 offen lds
  s_add_u32 m0, s15, 114688
  s_add_u32 s81, s81, 1
  buffer_load_dwordx4 v5, s[36:39], s12 offen lds
  s_add_u32 m0, s15, 122752
  s_cmp_ge_u32 s81, 7
  s_cselect_b32 s81, 0, s81
  buffer_load_dwordx4 v5, s[36:39], s12 offen offset:128 lds
  v_add_u32 v18, 81920, v12
  v_add_u32 v8, 65536, v8
  v_add_u32 v9, 65536, v9
  v_add_u32 v10, 65536, v10
  v_add_u32 v11, 65536, v11
  s_waitcnt vmcnt(4)
  s_waitcnt lgkmcnt(0)
  s_barrier
  v_mfma_f32_32x32x16_bf16 v[160:175], v[224:227], v[64:67], v[160:175]
  ds_read_b128 v[80:83], v8 offset:0
  ds_read_b64_tr_b16 v[208:209], v18 offset:0
  ds_read_b64_tr_b16 v[210:211], v18 offset:512
  v_mfma_f32_32x32x16_bf16 v[160:175], v[228:231], v[68:71], v[160:175]
  ds_read_b128 v[84:87], v9 offset:0
  ds_read_b64_tr_b16 v[212:213], v18 offset:2048
  ds_read_b64_tr_b16 v[214:215], v18 offset:2560
  v_mfma_f32_32x32x16_bf16 v[160:175], v[232:235], v[72:75], v[160:175]
  ds_read_b128 v[88:91], v10 offset:0
  ds_read_b64_tr_b16 v[216:217], v18 offset:4096
  ds_read_b64_tr_b16 v[218:219], v18 offset:4608
  v_mfma_f32_32x32x16_bf16 v[160:175], v[236:239], v[76:79], v[160:175]
  ds_read_b128 v[92:95], v11 offset:0
  ds_read_b64_tr_b16 v[220:221], v18 offset:6144
  ds_read_b64_tr_b16 v[222:223], v18 offset:6656
  s_add_u32 m0, s14, 0
  s_lshl_b32 s11, s81, 7
  buffer_load_dwordx4 v3, s[16:19], s11 offen lds
  s_add_u32 m0, s14, 1024
  s_mul_i32 s12, s81, 229376
  buffer_load_dwordx4 v4, s[16:19], s11 offen lds
  s_add_u32 m0, s15, 16384
  s_add_u32 s81, s81, 1
  buffer_load_dwordx4 v5, s[36:39], s12 offen lds
  s_add_u32 m0, s15, 24448
  s_cmp_ge_u32 s81, 7
  s_cselect_b32 s81, 0, s81
  buffer_load_dwordx4 v5, s[36:39], s12 offen offset:128 lds
  v_add_u32 v18, 114688, v12
  s_waitcnt vmcnt(4)
  s_waitcnt lgkmcnt(0)
  s_barrier
  v_mfma_f32_32x32x16_bf16 v[160:175], v[208:211], v[80:83], v[160:175]
  ds_read_b128 v[96:99], v8 offset:32768
  ds_read_b64_tr_b16 v[224:225], v18 offset:0
  ds_read_b64_tr_b16 v[226:227], v18 offset:512
  v_mfma_f32_32x32x16_bf16 v[160:175], v[212:215], v[84:87], v[160:175]
  ds_read_b128 v[100:103], v9 offset:32768
  ds_read_b64_tr_b16 v[228:229], v18 offset:2048
  ds_read_b64_tr_b16 v[230:231], v18 offset:2560
  v_mfma_f32_32x32x16_bf16 v[160:175], v[216:219], v[88:91], v[160:175]
  ds_read_b128 v[104:107], v10 offset:32768
  ds_read_b64_tr_b16 v[232:233], v18 offset:4096
  ds_read_b64_tr_b16 v[234:235], v18 offset:4608
  v_mfma_f32_32x32x16_bf16 v[160:175], v[220:223], v[92:95], v[160:175]
  ds_read_b128 v[108:111], v11 offset:32768
  ds_read_b64_tr_b16 v[236:237], v18 offset:6144
  ds_read_b64_tr_b16 v[238:239], v18 offset:6656
  s_add_u32 m0, s14, 32768
  s_lshl_b32 s11, s81, 7
  buffer_load_dwordx4 v3, s[16:19], s11 offen lds
  s_add_u32 m0, s14, 33792
  s_mul_i32 s12, s81, 229376
  buffer_load_dwordx4 v4, s[16:19], s11 offen lds
  s_add_u32 m0, s15, 49152
  s_add_u32 s81, s81, 1
  buffer_load_dwordx4 v5, s[36:39], s12 offen lds
  s_add_u32 m0, s15, 57216
  s_cmp_ge_u32 s81, 7
  s_cselect_b32 s81, 0, s81
  buffer_load_dwordx4 v5, s[36:39], s12 offen offset:128 lds
  v_add_u32 v18, 16384, v12
  v_subrev_u32 v8, 65536, v8
  v_subrev_u32 v9, 65536, v9
  v_subrev_u32 v10, 65536, v10
  v_subrev_u32 v11, 65536, v11
  s_waitcnt vmcnt(4)
  s_waitcnt lgkmcnt(0)
  s_barrier
  v_mfma_f32_32x32x16_bf16 v[160:175], v[224:227], v[96:99], v[160:175]
  ds_read_b128 v[112:115], v8 offset:0
  ds_read_b64_tr_b16 v[208:209], v18 offset:0
  ds_read_b64_tr_b16 v[210:211], v18 offset:512
  v_mfma_f32_32x32x16_bf16 v[160:175], v[228:231], v[100:103], v[160:175]
  ds_read_b128 v[116:119], v9 offset:0
  ds_read_b64_tr_b16 v[212:213], v18 offset:2048
  ds_read_b64_tr_b16 v[214:215], v18 offset:2560
  v_mfma_f32_32x32x16_bf16 v[160:175], v[232:235], v[104:107], v[160:175]
  ds_read_b128 v[120:123], v10 offset:0
  ds_read_b64_tr_b16 v[216:217], v18 offset:4096
  ds_read_b64_tr_b16 v[218:219], v18 offset:4608
  v_mfma_f32_32x32x16_bf16 v[160:175], v[236:239], v[108:111], v[160:175]
  ds_read_b128 v[124:127], v11 offset:0
  ds_read_b64_tr_b16 v[220:221], v18 offset:6144
  ds_read_b64_tr_b16 v[222:223], v18 offset:6656
  s_add_u32 m0, s14, 65536
  s_lshl_b32 s11, s81, 7
  buffer_load_dwordx4 v3, s[16:19], s11 offen lds
  s_add_u32 m0, s14, 66560
  s_mul_i32 s12, s81, 229376
  buffer_load_dwordx4 v4, s[16:19], s11 offen lds
  s_add_u32 m0, s15, 81920
  s_add_u32 s81, s81, 1
  buffer_load_dwordx4 v5, s[36:39], s12 offen lds
  s_add_u32 m0, s15, 89984
  s_cmp_ge_u32 s81, 7
  s_cselect_b32 s81, 0, s81
  buffer_load_dwordx4 v5, s[36:39], s12 offen offset:128 lds
  s_add_u32 s10, s8, 0
  s_add_u32 s11, s10, s69
  s_sub_u32 s72, s11, 7
  s_cmp_ge_u32 s11, 7
  s_cselect_b32 s11, s72, s11
  s_cmp_eq_u32 s10, 7
  s_cselect_b32 s11, 64, s11
  s_lshl_b32 s10, s3, 10
  s_add_u32 m0, s10, 131072
  s_mul_i32 s12, s11, 57344
  s_lshl_b32 s11, s11, 7
  buffer_load_dwordx4 v7, s[20:23], s12 offen lds
  buffer_load_ushort v32, v19, s[52:55], s11 offen
  v_add_u32 v18, 49152, v12
  s_waitcnt vmcnt(6)
  s_waitcnt lgkmcnt(0)
  s_barrier
  v_mfma_f32_32x32x16_bf16 v[160:175], v[208:211], v[112:115], v[160:175]
  ds_read_b128 v[128:131], v8 offset:32768
  ds_read_b64_tr_b16 v[224:225], v18 offset:0
  ds_read_b64_tr_b16 v[226:227], v18 offset:512
  v_mfma_f32_32x32x16_bf16 v[160:175], v[212:215], v[116:119], v[160:175]
  ds_read_b128 v[132:135], v9 offset:32768
  ds_read_b64_tr_b16 v[228:229], v18 offset:2048
  ds_read_b64_tr_b16 v[230:231], v18 offset:2560
  v_mfma_f32_32x32x16_bf16 v[160:175], v[216:219], v[120:123], v[160:175]
  ds_read_b128 v[136:139], v10 offset:32768
  ds_read_b64_tr_b16 v[232:233], v18 offset:4096
  ds_read_b64_tr_b16 v[234:235], v18 offset:4608
  v_mfma_f32_32x32x16_bf16 v[160:175], v[220:223], v[124:127], v[160:175]
  ds_read_b128 v[140:143], v11 offset:32768
  ds_read_b64_tr_b16 v[236:237], v18 offset:6144
  ds_read_b64_tr_b16 v[238:239], v18 offset:6656
  s_add_u32 s10, s8, 2
  s_add_u32 s11, s10, s69
  s_sub_u32 s72, s11, 7
  s_cmp_ge_u32 s11, 7
  s_cselect_b32 s11, s72, s11
  s_cmp_eq_u32 s10, 7
  s_cselect_b32 s11, 64, s11
  s_lshl_b32 s10, s3, 10
  s_add_u32 m0, s10, 139264
  s_mul_i32 s12, s11, 57344
  s_lshl_b32 s11, s11, 7
  buffer_load_dwordx4 v7, s[20:23], s12 offen lds
  buffer_load_ushort v34, v19, s[52:55], s11 offen
  s_add_u32 s10, s8, 4
  s_add_u32 s11, s10, s69
  s_sub_u32 s72, s11, 7
  s_cmp_ge_u32 s11, 7
  s_cselect_b32 s11, s72, s11
  s_cmp_eq_u32 s10, 7
  s_cselect_b32 s11, 64, s11
  s_lshl_b32 s10, s3, 10
  s_add_u32 m0, s10, 147456
  s_mul_i32 s12, s11, 57344
  s_lshl_b32 s11, s11, 7
  buffer_load_dwordx4 v7, s[20:23], s12 offen lds
  buffer_load_ushort v36, v19, s[52:55], s11 offen
  v_add_u32 v18, 81920, v12
  v_add_u32 v8, 65536, v8
  v_add_u32 v9, 65536, v9
  v_add_u32 v10, 65536, v10
  v_add_u32 v11, 65536, v11
  s_waitcnt vmcnt(6)
  s_waitcnt lgkmcnt(0)
  s_barrier
  v_mfma_f32_32x32x16_bf16 v[160:175], v[224:227], v[128:131], v[160:175]
  ds_read_b128 v[144:147], v8 offset:0
  ds_read_b64_tr_b16 v[208:209], v18 offset:0
  ds_read_b64_tr_b16 v[210:211], v18 offset:512
  v_mfma_f32_32x32x16_bf16 v[160:175], v[228:231], v[132:135], v[160:175]
  ds_read_b128 v[148:151], v9 offset:0
  ds_read_b64_tr_b16 v[212:213], v18 offset:2048
  ds_read_b64_tr_b16 v[214:215], v18 offset:2560
  v_mfma_f32_32x32x16_bf16 v[160:175], v[232:235], v[136:139], v[160:175]
  ds_read_b128 v[152:155], v10 offset:0
  ds_read_b64_tr_b16 v[216:217], v18 offset:4096
  ds_read_b64_tr_b16 v[218:219], v18 offset:4608
  v_mfma_f32_32x32x16_bf16 v[160:175], v[236:239], v[140:143], v[160:175]
  ds_read_b128 v[156:159], v11 offset:0
  ds_read_b64_tr_b16 v[220:221], v18 offset:6144
  ds_read_b64_tr_b16 v[222:223], v18 offset:6656
  s_add_u32 s10, s8, 6
  s_add_u32 s11, s10, s69
  s_sub_u32 s72, s11, 7
  s_cmp_ge_u32 s11, 7
  s_cselect_b32 s11, s72, s11
  s_cmp_eq_u32 s10, 7
  s_cselect_b32 s11, 64, s11
  s_lshl_b32 s10, s3, 10
  s_add_u32 m0, s10, 155648
  s_mul_i32 s12, s11, 57344
  s_lshl_b32 s11, s11, 7
  buffer_load_dwordx4 v7, s[20:23], s12 offen lds
  buffer_load_ushort v38, v19, s[52:55], s11 offen
  s_lshl_b32 s10, s7, 4
  s_add_u32 s10, s10, s5
  s_lshl_b32 s10, s10, 1
  s_add_u32 s10, s10, s8
  s_lshl_b32 s10, s10, 10
  s_add_u32 s10, s10, s68
  s_add_u32 s10, s10, 524288
  v_mov_b32 v40, -1
  v_mov_b32 v41, -1
  v_mov_b32 v42, -1
  v_mov_b32 v43, -1
  buffer_store_dwordx4 v[40:43], v2, s[64:67], s10 offen sc1
  buffer_load_dwordx2 v[24:25], v15, s[60:63], 0 offen sc1
  s_waitcnt lgkmcnt(0)
  v_mfma_f32_32x32x16_bf16 v[160:175], v[208:211], v[144:147], v[160:175]
  v_mfma_f32_32x32x16_bf16 v[160:175], v[212:215], v[148:151], v[160:175]
  v_mfma_f32_32x32x16_bf16 v[160:175], v[216:219], v[152:155], v[160:175]
  v_mfma_f32_32x32x16_bf16 v[160:175], v[220:223], v[156:159], v[160:175]
  s_nop 11
  v_pk_mul_f32 v[208:209], v[160:161], v[160:161]
  v_pk_mul_f32 v[210:211], v[162:163], v[162:163]
  v_pk_mul_f32 v[212:213], v[164:165], v[164:165]
  v_pk_mul_f32 v[214:215], v[166:167], v[166:167]
  v_pk_mul_f32 v[216:217], v[168:169], v[168:169]
  v_pk_mul_f32 v[218:219], v[170:171], v[170:171]
  v_pk_mul_f32 v[220:221], v[172:173], v[172:173]
  v_pk_mul_f32 v[222:223], v[174:175], v[174:175]
  v_pk_fma_f32 v[208:209], v[208:209], s[70:71], v[30:31]
  v_pk_fma_f32 v[210:211], v[210:211], s[70:71], v[30:31]
  v_pk_fma_f32 v[212:213], v[212:213], s[70:71], v[30:31]
  v_pk_fma_f32 v[214:215], v[214:215], s[70:71], v[30:31]
  v_pk_fma_f32 v[216:217], v[216:217], s[70:71], v[30:31]
  v_pk_fma_f32 v[218:219], v[218:219], s[70:71], v[30:31]
  v_pk_fma_f32 v[220:221], v[220:221], s[70:71], v[30:31]
  v_pk_fma_f32 v[222:223], v[222:223], s[70:71], v[30:31]
  v_pk_mul_f32 v[208:209], v[208:209], v[160:161]
  v_pk_mul_f32 v[210:211], v[210:211], v[162:163]
  v_pk_mul_f32 v[212:213], v[212:213], v[164:165]
  v_pk_mul_f32 v[214:215], v[214:215], v[166:167]
  v_pk_mul_f32 v[216:217], v[216:217], v[168:169]
  v_pk_mul_f32 v[218:219], v[218:219], v[170:171]
  v_pk_mul_f32 v[220:221], v[220:221], v[172:173]
  v_pk_mul_f32 v[222:223], v[222:223], v[174:175]
  v_exp_f32 v208, v208
  v_exp_f32 v209, v209
  v_exp_f32 v210, v210
  v_exp_f32 v211, v211
  v_exp_f32 v212, v212
  v_exp_f32 v213, v213
  v_exp_f32 v214, v214
  v_exp_f32 v215, v215
  v_exp_f32 v216, v216
  v_exp_f32 v217, v217
  v_exp_f32 v218, v218
  v_exp_f32 v219, v219
  v_exp_f32 v220, v220
  v_exp_f32 v221, v221
  v_exp_f32 v222, v222
  v_exp_f32 v223, v223
  v_pk_add_f32 v[208:209], v[208:209], 1.0 op_sel_hi:[1,0]
  v_pk_add_f32 v[210:211], v[210:211], 1.0 op_sel_hi:[1,0]
  v_pk_add_f32 v[212:213], v[212:213], 1.0 op_sel_hi:[1,0]
  v_pk_add_f32 v[214:215], v[214:215], 1.0 op_sel_hi:[1,0]
  v_pk_add_f32 v[216:217], v[216:217], 1.0 op_sel_hi:[1,0]
  v_pk_add_f32 v[218:219], v[218:219], 1.0 op_sel_hi:[1,0]
  v_pk_add_f32 v[220:221], v[220:221], 1.0 op_sel_hi:[1,0]
  v_pk_add_f32 v[222:223], v[222:223], 1.0 op_sel_hi:[1,0]
  v_rcp_f32 v208, v208
  v_rcp_f32 v209, v209
  v_rcp_f32 v210, v210
  v_rcp_f32 v211, v211
  v_rcp_f32 v212, v212
  v_rcp_f32 v213, v213
  v_rcp_f32 v214, v214
  v_rcp_f32 v215, v215
  v_rcp_f32 v216, v216
  v_rcp_f32 v217, v217
  v_rcp_f32 v218, v218
  v_rcp_f32 v219, v219
  v_rcp_f32 v220, v220
  v_rcp_f32 v221, v221
  v_rcp_f32 v222, v222
  v_rcp_f32 v223, v223
  v_pk_mul_f32 v[208:209], v[208:209], v[160:161]
  v_pk_mul_f32 v[210:211], v[210:211], v[162:163]
  v_pk_mul_f32 v[212:213], v[212:213], v[164:165]
  v_pk_mul_f32 v[214:215], v[214:215], v[166:167]
  v_pk_mul_f32 v[216:217], v[216:217], v[168:169]
  v_pk_mul_f32 v[218:219], v[218:219], v[170:171]
  v_pk_mul_f32 v[220:221], v[220:221], v[172:173]
  v_pk_mul_f32 v[222:223], v[222:223], v[174:175]
  v_cvt_pk_bf16_f32 v160, v208, v209
  v_cvt_pk_bf16_f32 v161, v210, v211
  v_cvt_pk_bf16_f32 v162, v212, v213
  v_cvt_pk_bf16_f32 v163, v214, v215
  v_cvt_pk_bf16_f32 v164, v216, v217
  v_cvt_pk_bf16_f32 v165, v218, v219
  v_cvt_pk_bf16_f32 v166, v220, v221
  v_cvt_pk_bf16_f32 v167, v222, v223
  s_waitcnt vmcnt(0)
  ds_write_b64 v14, v[32:33] offset:0
  ds_write_b64 v14, v[34:35] offset:8192
  ds_write_b64 v14, v[36:37] offset:16384
  ds_write_b64 v14, v[38:39] offset:24576
  s_mov_b32 s80, 0
tok2:
  v_cmp_ne_u32 vcc, 0, v24
  s_nop 1
  s_cbranch_vccnz tok2_ok
  s_sleep 1
  buffer_load_dwordx2 v[24:25], v15, s[60:63], 0 offen sc1
  s_waitcnt vmcnt(0)
  s_add_u32 s80, s80, 1
  s_cmp_lt_u32 s80, 20000000
  s_cbranch_scc1 tok2
tok2_ok:
  s_waitcnt lgkmcnt(0)
  s_barrier
  buffer_store_dwordx4 v[160:163], v2, s[64:67], s76 offen offset:0 sc1
  buffer_store_dwordx4 v[164:167], v2, s[64:67], s76 offen offset:1024 sc1
  ds_read_b64_tr_b16 v[224:225], v13 offset:0
  ds_read_b64_tr_b16 v[226:227], v13 offset:256
  ds_read_b64_tr_b16 v[228:229], v13 offset:1024
  ds_read_b64_tr_b16 v[230:231], v13 offset:1280
  ds_read_b64_tr_b16 v[232:233], v13 offset:2048
  ds_read_b64_tr_b16 v[234:235], v13 offset:2304
  ds_read_b64_tr_b16 v[236:237], v13 offset:3072
  ds_read_b64_tr_b16 v[238:239], v13 offset:3328
  s_waitcnt lgkmcnt(6)
  v_mfma_f32_32x32x16_bf16 v[192:207], v[224:227], v[48:51], 0
  ds_read_b64_tr_b16 v[224:225], v13 offset:4096
  ds_read_b64_tr_b16 v[226:227], v13 offset:4352
  s_waitcnt lgkmcnt(6)
  v_mfma_f32_32x32x16_bf16 v[192:207], v[228:231], v[52:55], v[192:207]
  ds_read_b64_tr_b16 v[228:229], v13 offset:5120
  ds_read_b64_tr_b16 v[230:231], v13 offset:5376
  s_waitcnt lgkmcnt(6)
  v_mfma_f32_32x32x16_bf16 v[192:207], v[232:235], v[56:59], v[192:207]
  ds_read_b64_tr_b16 v[232:233], v13 offset:6144
  ds_read_b64_tr_b16 v[234:235], v13 offset:6400
  s_waitcnt lgkmcnt(6)
  v_mfma_f32_32x32x16_bf16 v[192:207], v[236:239], v[60:63], v[192:207]
  ds_read_b64_tr_b16 v[236:237], v13 offset:7168
  ds_read_b64_tr_b16 v[238:239], v13 offset:7424
  s_waitcnt lgkmcnt(6)
  v_mfma_f32_32x32x16_bf16 v[192:207], v[224:227], v[64:67], v[192:207]
  ds_read_b64_tr_b16 v[224:225], v13 offset:8192
  ds_read_b64_tr_b16 v[226:227], v13 offset:8448
  s_waitcnt lgkmcnt(6)
  v_mfma_f32_32x32x16_bf16 v[192:207], v[228:231], v[68:71], v[192:207]
  ds_read_b64_tr_b16 v[228:229], v13 offset:9216
  ds_read_b64_tr_b16 v[230:231], v13 offset:9472
  s_waitcnt lgkmcnt(6)
  v_mfma_f32_32x32x16_bf16 v[192:207], v[232:235], v[72:75], v[192:207]
  ds_read_b64_tr_b16 v[232:233], v13 offset:10240
  ds_read_b64_tr_b16 v[234:235], v13 offset:10496
  s_waitcnt lgkmcnt(6)
  v_mfma_f32_32x32x16_bf16 v[192:207], v[236:239], v[76:79], v[192:207]
  ds_read_b64_tr_b16 v[236:237], v13 offset:11264
  ds_read_b64_tr_b16 v[238:239], v13 offset:11520
  s_waitcnt lgkmcnt(6)
  v_mfma_f32_32x32x16_bf16 v[192:207], v[224:227], v[80:83], v[192:207]
  ds_read_b64_tr_b16 v[224:225], v13 offset:12288
  ds_read_b64_tr_b16 v[226:227], v13 offset:12544
  s_waitcnt lgkmcnt(6)
  v_mfma_f32_32x32x16_bf16 v[192:207], v[228:231], v[84:87], v[192:207]
  ds_read_b64_tr_b16 v[228:229], v13 offset:13312
  ds_read_b64_tr_b16 v[230:231], v13 offset:13568
  s_waitcnt lgkmcnt(6)
  v_mfma_f32_32x32x16_bf16 v[192:207], v[232:235], v[88:91], v[192:207]
  ds_read_b64_tr_b16 v[232:233], v13 offset:14336
  ds_read_b64_tr_b16 v[234:235], v13 offset:14592
  s_waitcnt lgkmcnt(6)
  v_mfma_f32_32x32x16_bf16 v[192:207], v[236:239], v[92:95], v[192:207]
  ds_read_b64_tr_b16 v[236:237], v13 offset:15360
  ds_read_b64_tr_b16 v[238:239], v13 offset:15616
  s_waitcnt lgkmcnt(6)
  v_mfma_f32_32x32x16_bf16 v[192:207], v[224:227], v[96:99], v[192:207]
  ds_read_b64_tr_b16 v[224:225], v13 offset:16384
  ds_read_b64_tr_b16 v[226:227], v13 offset:16640
  s_waitcnt lgkmcnt(6)
  v_mfma_f32_32x32x16_bf16 v[192:207], v[228:231], v[100:103], v[192:207]
  ds_read_b64_tr_b16 v[228:229], v13 offset:17408
  ds_read_b64_tr_b16 v[230:231], v13 offset:17664
  s_waitcnt lgkmcnt(6)
  v_mfma_f32_32x32x16_bf16 v[192:207], v[232:235], v[104:107], v[192:207]
  ds_read_b64_tr_b16 v[232:233], v13 offset:18432
  ds_read_b64_tr_b16 v[234:235], v13 offset:18688
  s_waitcnt lgkmcnt(6)
  v_mfma_f32_32x32x16_bf16 v[192:207], v[236:239], v[108:111], v[192:207]
  ds_read_b64_tr_b16 v[236:237], v13 offset:19456
  ds_read_b64_tr_b16 v[238:239], v13 offset:19712
  s_waitcnt lgkmcnt(6)
  v_mfma_f32_32x32x16_bf16 v[192:207], v[224:227], v[112:115], v[192:207]
  ds_read_b64_tr_b16 v[224:225], v13 offset:20480
  ds_read_b64_tr_b16 v[226:227], v13 offset:20736
  s_waitcnt lgkmcnt(6)
  v_mfma_f32_32x32x16_bf16 v[192:207], v[228:231], v[116:119], v[192:207]
  ds_read_b64_tr_b16 v[228:229], v13 offset:21504
  ds_read_b64_tr_b16 v[230:231], v13 offset:21760
  s_waitcnt lgkmcnt(6)
  v_mfma_f32_32x32x16_bf16 v[192:207], v[232:235], v[120:123], v[192:207]
  ds_read_b64_tr_b16 v[232:233], v13 offset:22528
  ds_read_b64_tr_b16 v[234:235], v13 offset:22784
  s_waitcnt lgkmcnt(6)
  v_mfma_f32_32x32x16_bf16 v[192:207], v[236:239], v[124:127], v[192:207]
  ds_read_b64_tr_b16 v[236:237], v13 offset:23552
  ds_read_b64_tr_b16 v[238:239], v13 offset:23808
  s_waitcnt lgkmcnt(6)
  v_mfma_f32_32x32x16_bf16 v[192:207], v[224:227], v[128:131], v[192:207]
  ds_read_b64_tr_b16 v[224:225], v13 offset:24576
  ds_read_b64_tr_b16 v[226:227], v13 offset:24832
  s_waitcnt lgkmcnt(6)
  v_mfma_f32_32x32x16_bf16 v[192:207], v[228:231], v[132:135], v[192:207]
  ds_read_b64_tr_b16 v[228:229], v13 offset:25600
  ds_read_b64_tr_b16 v[230:231], v13 offset:25856
  s_waitcnt lgkmcnt(6)
  v_mfma_f32_32x32x16_bf16 v[192:207], v[232:235], v[136:139], v[192:207]
  ds_read_b64_tr_b16 v[232:233], v13 offset:26624
  ds_read_b64_tr_b16 v[234:235], v13 offset:26880
  s_waitcnt lgkmcnt(6)
  v_mfma_f32_32x32x16_bf16 v[192:207], v[236:239], v[140:143], v[192:207]
  ds_read_b64_tr_b16 v[236:237], v13 offset:27648
  ds_read_b64_tr_b16 v[238:239], v13 offset:27904
  s_waitcnt lgkmcnt(6)
  v_mfma_f32_32x32x16_bf16 v[192:207], v[224:227], v[144:147], v[192:207]
  s_waitcnt lgkmcnt(4)
  v_mfma_f32_32x32x16_bf16 v[192:207], v[228:231], v[148:151], v[192:207]
  s_waitcnt lgkmcnt(2)
  v_mfma_f32_32x32x16_bf16 v[192:207], v[232:235], v[152:155], v[192:207]
  s_waitcnt lgkmcnt(0)
  v_mfma_f32_32x32x16_bf16 v[192:207], v[236:239], v[156:159], v[192:207]
  s_lshl_b32 s10, s7, 8
  s_add_u32 s10, s10, 110592
  v_lshl_add_u32 v18, v1, 2, s10
  s_nop 8
  v_mul_f32 v28, 0xbfb8aa3b, v204
  v_exp_f32 v28, v28
  s_mov_b32 exec_lo, 0
  v_mov_b32 v204, 0
  v_mov_b32 v205, 0
  v_mov_b32 v206, 0
  v_mov_b32 v207, 0
  s_mov_b64 exec, -1
  v_add_f32 v28, 1.0, v28
  v_rcp_f32 v28, v28
  s_mov_b32 s74, 0x3e8b97f6
  s_mov_b32 s75, 0x3e8b97f6
  v_pk_mul_f32 v[192:193], v[192:193], s[74:75]
  v_pk_mul_f32 v[194:195], v[194:195], s[74:75]
  v_pk_mul_f32 v[196:197], v[196:197], s[74:75]
  v_pk_mul_f32 v[198:199], v[198:199], s[74:75]
  v_mov_b32 v29, v28
  v_pk_mul_f32 v[200:201], v[200:201], s[74:75]
  v_pk_mul_f32 v[202:203], v[202:203], s[74:75]
  v_pk_mul_f32 v[204:205], v[204:205], s[74:75]
  v_pk_mul_f32 v[206:207], v[206:207], s[74:75]
  v_permlane32_swap_b32 v29, v28
  v_cvt_pk_bf16_f32 v40, v192, v193
  v_cvt_pk_bf16_f32 v41, v194, v195
  v_cvt_pk_bf16_f32 v42, v196, v197
  v_cvt_pk_bf16_f32 v43, v198, v199
  v_cvt_pk_bf16_f32 v44, v200, v201
  v_cvt_pk_bf16_f32 v45, v202, v203
  v_cvt_pk_bf16_f32 v46, v204, v205
  v_cvt_pk_bf16_f32 v47, v206, v207
  ds_write_b32 v18, v28
  s_waitcnt lgkmcnt(0)
  s_barrier
  s_branch L_attn
L_ffn_B:
  v_add_u32 v18, 16384, v12
  v_xor_b32 v16, 64, v18
  s_waitcnt vmcnt(4)
  s_barrier
  ds_read_b128 v[48:51], v8 offset:0
  ds_read_b64_tr_b16 v[80:81], v18 offset:0
  ds_read_b64_tr_b16 v[82:83], v18 offset:512
  ds_read_b64_tr_b16 v[112:113], v16 offset:8192
  ds_read_b64_tr_b16 v[114:115], v16 offset:8704
  ds_read_b64_tr_b16 v[208:209], v18 offset:8192
  ds_read_b64_tr_b16 v[210:211], v18 offset:8704
  ds_read_b128 v[52:55], v9 offset:0
  ds_read_b64_tr_b16 v[84:85], v18 offset:2048
  ds_read_b64_tr_b16 v[86:87], v18 offset:2560
  ds_read_b64_tr_b16 v[116:117], v16 offset:10240
  ds_read_b64_tr_b16 v[118:119], v16 offset:10752
  ds_read_b64_tr_b16 v[212:213], v18 offset:10240
  ds_read_b64_tr_b16 v[214:215], v18 offset:10752
  ds_read_b128 v[56:59], v10 offset:0
  ds_read_b64_tr_b16 v[88:89], v18 offset:4096
  ds_read_b64_tr_b16 v[90:91], v18 offset:4608
  ds_read_b64_tr_b16 v[120:121], v16 offset:12288
  ds_read_b64_tr_b16 v[122:123], v16 offset:12800
  ds_read_b64_tr_b16 v[216:217], v18 offset:12288
  ds_read_b64_tr_b16 v[218:219], v18 offset:12800
  ds_read_b128 v[60:63], v11 offset:0
  ds_read_b64_tr_b16 v[92:93], v18 offset:6144
  ds_read_b64_tr_b16 v[94:95], v18 offset:6656
  ds_read_b64_tr_b16 v[124:125], v16 offset:14336
  ds_read_b64_tr_b16 v[126:127], v16 offset:14848
  ds_read_b64_tr_b16 v[220:221], v18 offset:14336
  ds_read_b64_tr_b16 v[222:223], v18 offset:14848
  v_mfma_f32_32x32x16_bf16 v[160:175], v[240:243], v[44:47], 0
  v_mfma_f32_32x32x16_bf16 v[176:191], v[244:247], v[44:47], 0
  v_mfma_f32_32x32x16_bf16 v[192:207], v[248:251], v[44:47], 0
  s_add_u32 m0, s14, 65536
  s_lshl_b32 s11, s81, 7
  buffer_load_dwordx4 v3, s[16:19], s11 offen lds
  s_add_u32 m0, s14, 66560
  s_mul_i32 s12, s81, 229376
  buffer_load_dwordx4 v4, s[16:19], s11 offen lds
  s_add_u32 m0, s15, 81920
  s_add_u32 s81, s81, 1
  buffer_load_dwordx4 v5, s[36:39], s12 offen lds
  s_add_u32 m0, s15, 89984
  s_cmp_ge_u32 s81, 7
  s_cselect_b32 s81, 0, s81
  buffer_load_dwordx4 v5, s[36:39], s12 offen offset:128 lds
  v_add_u32 v18, 49152, v12
  v_xor_b32 v16, 64, v18
  s_waitcnt vmcnt(4)
  s_waitcnt lgkmcnt(0)
  s_barrier
  v_mfma_f32_32x32x16_bf16 v[160:175], v[80:83], v[48:51], v[160:175]
  ds_read_b128 v[64:67], v8 offset:32768
  ds_read_b64_tr_b16 v[96:97], v18 offset:0
  ds_read_b64_tr_b16 v[98:99], v18 offset:512
  v_mfma_f32_32x32x16_bf16 v[176:191], v[112:115], v[48:51], v[176:191]
  ds_read_b64_tr_b16 v[128:129], v16 offset:8192
  ds_read_b64_tr_b16 v[130:131], v16 offset:8704
  v_mfma_f32_32x32x16_bf16 v[192:207], v[208:211], v[48:51], v[192:207]
  ds_read_b64_tr_b16 v[224:225], v18 offset:8192
  ds_read_b64_tr_b16 v[226:227], v18 offset:8704
  v_mfma_f32_32x32x16_bf16 v[160:175], v[84:87], v[52:55], v[160:175]
  ds_read_b128 v[68:71], v9 offset:32768
  ds_read_b64_tr_b16 v[100:101], v18 offset:2048
  ds_read_b64_tr_b16 v[102:103], v18 offset:2560
  v_mfma_f32_32x32x16_bf16 v[176:191], v[116:119], v[52:55], v[176:191]
  ds_read_b64_tr_b16 v[132:133], v16 offset:10240
  ds_read_b64_tr_b16 v[134:135], v16 offset:10752
  v_mfma_f32_32x32x16_bf16 v[192:207], v[212:215], v[52:55], v[192:207]
  ds_read_b64_tr_b16 v[228:229], v18 offset:10240
  ds_read_b64_tr_b16 v[230:231], v18 offset:10752
  v_mfma_f32_32x32x16_bf16 v[160:175], v[88:91], v[56:59], v[160:175]
  ds_read_b128 v[72:75], v10 offset:32768
  ds_read_b64_tr_b16 v[104:105], v18 offset:4096
  ds_read_b64_tr_b16 v[106:107], v18 offset:4608
  v_mfma_f32_32x32x16_bf16 v[176:191], v[120:123], v[56:59], v[176:191]
  ds_read_b64_tr_b16 v[136:137], v16 offset:12288
  ds_read_b64_tr_b16 v[138:139], v16 offset:12800
  v_mfma_f32_32x32x16_bf16 v[192:207], v[216:219], v[56:59], v[192:207]
  ds_read_b64_tr_b16 v[232:233], v18 offset:12288
  ds_read_b64_tr_b16 v[234:235], v18 offset:12800
  v_mfma_f32_32x32x16_bf16 v[160:175], v[92:95], v[60:63], v[160:175]
  ds_read_b128 v[76:79], v11 offset:32768
  ds_read_b64_tr_b16 v[108:109], v18 offset:6144
  ds_read_b64_tr_b16 v[110:111], v18 offset:6656
  v_mfma_f32_32x32x16_bf16 v[176:191], v[124:127], v[60:63], v[176:191]
  ds_read_b64_tr_b16 v[140:141], v16 offset:14336
  ds_read_b64_tr_b16 v[142:143], v16 offset:14848
  v_mfma_f32_32x32x16_bf16 v[192:207], v[220:223], v[60:63], v[192:207]
  ds_read_b64_tr_b16 v[236:237], v18 offset:14336
  ds_read_b64_tr_b16 v[238:239], v18 offset:14848
  s_add_u32 m0, s14, 98304
  s_lshl_b32 s11, s81, 7
  buffer_load_dwordx4 v3, s[16:19], s11 offen lds
  s_add_u32 m0, s14, 99328
  s_mul_i32 s12, s81, 229376
  buffer_load_dwordx4 v4, s[16:19], s11 offen lds
  s_add_u32 m0, s15, 114688
  s_add_u32 s81, s81, 1
  buffer_load_dwordx4 v5, s[36:39], s12 offen lds
  s_add_u32 m0, s15, 122752
  s_cmp_ge_u32 s81, 7
  s_cselect_b32 s81, 0, s81
  buffer_load_dwordx4 v5, s[36:39], s12 offen offset:128 lds
  v_add_u32 v18, 81920, v12
  v_xor_b32 v16, 64, v18
  v_add_u32 v8, 65536, v8
  v_add_u32 v9, 65536, v9
  v_add_u32 v10, 65536, v10
  v_add_u32 v11, 65536, v11
  s_waitcnt vmcnt(4)
  s_waitcnt lgkmcnt(0)
  s_barrier
  v_mfma_f32_32x32x16_bf16 v[160:175], v[96:99], v[64:67], v[160:175]
  ds_read_b128 v[48:51], v8 offset:0
  ds_read_b64_tr_b16 v[80:81], v18 offset:0
  ds_read_b64_tr_b16 v[82:83], v18 offset:512
  v_mfma_f32_32x32x16_bf16 v[176:191], v[128:131], v[64:67], v[176:191]
  ds_read_b64_tr_b16 v[112:113], v16 offset:8192
  ds_read_b64_tr_b16 v[114:115], v16 offset:8704
  v_mfma_f32_32x32x16_bf16 v[192:207], v[224:227], v[64:67], v[192:207]
  ds_read_b64_tr_b16 v[208:209], v18 offset:8192
  ds_read_b64_tr_b16 v[210:211], v18 offset:8704
  v_mfma_f32_32x32x16_bf16 v[160:175], v[100:103], v[68:71], v[160:175]
  ds_read_b128 v[52:55], v9 offset:0
  ds_read_b64_tr_b16 v[84:85], v18 offset:2048
  ds_read_b64_tr_b16 v[86:87], v18 offset:2560
  v_mfma_f32_32x32x16_bf16 v[176:191], v[132:135], v[68:71], v[176:191]
  ds_read_b64_tr_b16 v[116:117], v16 offset:10240
  ds_read_b64_tr_b16 v[118:119], v16 offset:10752
  v_mfma_f32_32x32x16_bf16 v[192:207], v[228:231], v[68:71], v[192:207]
  ds_read_b64_tr_b16 v[212:213], v18 offset:10240
  ds_read_b64_tr_b16 v[214:215], v18 offset:10752
  v_mfma_f32_32x32x16_bf16 v[160:175], v[104:107], v[72:75], v[160:175]
  ds_read_b128 v[56:59], v10 offset:0
  ds_read_b64_tr_b16 v[88:89], v18 offset:4096
  ds_read_b64_tr_b16 v[90:91], v18 offset:4608
  v_mfma_f32_32x32x16_bf16 v[176:191], v[136:139], v[72:75], v[176:191]
  ds_read_b64_tr_b16 v[120:121], v16 offset:12288
  ds_read_b64_tr_b16 v[122:123], v16 offset:12800
  v_mfma_f32_32x32x16_bf16 v[192:207], v[232:235], v[72:75], v[192:207]
  ds_read_b64_tr_b16 v[216:217], v18 offset:12288
  ds_read_b64_tr_b16 v[218:219], v18 offset:12800
  v_mfma_f32_32x32x16_bf16 v[160:175], v[108:111], v[76:79], v[160:175]
  ds_read_b128 v[60:63], v11 offset:0
  ds_read_b64_tr_b16 v[92:93], v18 offset:6144
  ds_read_b64_tr_b16 v[94:95], v18 offset:6656
  v_mfma_f32_32x32x16_bf16 v[176:191], v[140:143], v[76:79], v[176:191]
  ds_read_b64_tr_b16 v[124:125], v16 offset:14336
  ds_read_b64_tr_b16 v[126:127], v16 offset:14848
  v_mfma_f32_32x32x16_bf16 v[192:207], v[236:239], v[76:79], v[192:207]
  ds_read_b64_tr_b16 v[220:221], v18 offset:14336
  ds_read_b64_tr_b16 v[222:223], v18 offset:14848
  s_add_u32 m0, s14, 0
  s_lshl_b32 s11, s81, 7
  buffer_load_dwordx4 v3, s[16:19], s11 offen lds
  s_add_u32 m0, s14, 1024
  s_mul_i32 s12, s81, 229376
  buffer_load_dwordx4 v4, s[16:19], s11 offen lds
  s_add_u32 m0, s15, 16384
  s_add_u32 s81, s81, 1
  buffer_load_dwordx4 v5, s[36:39], s12 offen lds
  s_add_u32 m0, s15, 24448
  s_cmp_ge_u32 s81, 7
  s_cselect_b32 s81, 0, s81
  buffer_load_dwordx4 v5, s[36:39], s12 offen offset:128 lds
  v_add_u32 v18, 114688, v12
  v_xor_b32 v16, 64, v18
  s_waitcnt vmcnt(4)
  s_waitcnt lgkmcnt(0)
  s_barrier
  v_mfma_f32_32x32x16_bf16 v[160:175], v[80:83], v[48:51], v[160:175]
  ds_read_b128 v[64:67], v8 offset:32768
  ds_read_b64_tr_b16 v[96:97], v18 offset:0
  ds_read_b64_tr_b16 v[98:99], v18 offset:512
  v_mfma_f32_32x32x16_bf16 v[176:191], v[112:115], v[48:51], v[176:191]
  ds_read_b64_tr_b16 v[128:129], v16 offset:8192
  ds_read_b64_tr_b16 v[130:131], v16 offset:8704
  v_mfma_f32_32x32x16_bf16 v[192:207], v[208:211], v[48:51], v[192:207]
  ds_read_b64_tr_b16 v[224:225], v18 offset:8192
  ds_read_b64_tr_b16 v[226:227], v18 offset:8704
  v_mfma_f32_32x32x16_bf16 v[160:175], v[84:87], v[52:55], v[160:175]
  ds_read_b128 v[68:71], v9 offset:32768
  ds_read_b64_tr_b16 v[100:101], v18 offset:2048
  ds_read_b64_tr_b16 v[102:103], v18 offset:2560
  v_mfma_f32_32x32x16_bf16 v[176:191], v[116:119], v[52:55], v[176:191]
  ds_read_b64_tr_b16 v[132:133], v16 offset:10240
  ds_read_b64_tr_b16 v[134:135], v16 offset:10752
  v_mfma_f32_32x32x16_bf16 v[192:207], v[212:215], v[52:55], v[192:207]
  ds_read_b64_tr_b16 v[228:229], v18 offset:10240
  ds_read_b64_tr_b16 v[230:231], v18 offset:10752
  v_mfma_f32_32x32x16_bf16 v[160:175], v[88:91], v[56:59], v[160:175]
  ds_read_b128 v[72:75], v10 offset:32768
  ds_read_b64_tr_b16 v[104:105], v18 offset:4096
  ds_read_b64_tr_b16 v[106:107], v18 offset:4608
  v_mfma_f32_32x32x16_bf16 v[176:191], v[120:123], v[56:59], v[176:191]
  ds_read_b64_tr_b16 v[136:137], v16 offset:12288
  ds_read_b64_tr_b16 v[138:139], v16 offset:12800
  v_mfma_f32_32x32x16_bf16 v[192:207], v[216:219], v[56:59], v[192:207]
  ds_read_b64_tr_b16 v[232:233], v18 offset:12288
  ds_read_b64_tr_b16 v[234:235], v18 offset:12800
  v_mfma_f32_32x32x16_bf16 v[160:175], v[92:95], v[60:63], v[160:175]
  ds_read_b128 v[76:79], v11 offset:32768
  ds_read_b64_tr_b16 v[108:109], v18 offset:6144
  ds_read_b64_tr_b16 v[110:111], v18 offset:6656
  v_mfma_f32_32x32x16_bf16 v[176:191], v[124:127], v[60:63], v[176:191]
  ds_read_b64_tr_b16 v[140:141], v16 offset:14336
  ds_read_b64_tr_b16 v[142:143], v16 offset:14848
  v_mfma_f32_32x32x16_bf16 v[192:207], v[220:223], v[60:63], v[192:207]
  ds_read_b64_tr_b16 v[236:237], v18 offset:14336
  ds_read_b64_tr_b16 v[238:239], v18 offset:14848
  s_add_u32 m0, s14, 32768
  s_lshl_b32 s11, s81, 7
  buffer_load_dwordx4 v3, s[16:19], s11 offen lds
  s_add_u32 m0, s14, 33792
  s_mul_i32 s12, s81, 229376
  buffer_load_dwordx4 v4, s[16:19], s11 offen lds
  s_add_u32 m0, s15, 49152
  s_add_u32 s81, s81, 1
  buffer_load_dwordx4 v5, s[36:39], s12 offen lds
  s_add_u32 m0, s15, 57216
  s_cmp_ge_u32 s81, 7
  s_cselect_b32 s81, 0, s81
  buffer_load_dwordx4 v5, s[36:39], s12 offen offset:128 lds
  v_add_u32 v18, 16384, v12
  v_xor_b32 v16, 64, v18
  v_subrev_u32 v8, 65536, v8
  v_subrev_u32 v9, 65536, v9
  v_subrev_u32 v10, 65536, v10
  v_subrev_u32 v11, 65536, v11
  s_waitcnt vmcnt(4)
  s_waitcnt lgkmcnt(0)
  s_barrier
  v_mfma_f32_32x32x16_bf16 v[160:175], v[96:99], v[64:67], v[160:175]
  ds_read_b128 v[48:51], v8 offset:0
  ds_read_b64_tr_b16 v[80:81], v18 offset:0
  ds_read_b64_tr_b16 v[82:83], v18 offset:512
  v_mfma_f32_32x32x16_bf16 v[176:191], v[128:131], v[64:67], v[176:191]
  ds_read_b64_tr_b16 v[112:113], v16 offset:8192
  ds_read_b64_tr_b16 v[114:115], v16 offset:8704
  v_mfma_f32_32x32x16_bf16 v[192:207], v[224:227], v[64:67], v[192:207]
  ds_read_b64_tr_b16 v[208:209], v18 offset:8192
  ds_read_b64_tr_b16 v[210:211], v18 offset:8704
  v_mfma_f32_32x32x16_bf16 v[160:175], v[100:103], v[68:71], v[160:175]
  ds_read_b128 v[52:55], v9 offset:0
  ds_read_b64_tr_b16 v[84:85], v18 offset:2048
  ds_read_b64_tr_b16 v[86:87], v18 offset:2560
  v_mfma_f32_32x32x16_bf16 v[176:191], v[132:135], v[68:71], v[176:191]
  ds_read_b64_tr_b16 v[116:117], v16 offset:10240
  ds_read_b64_tr_b16 v[118:119], v16 offset:10752
  v_mfma_f32_32x32x16_bf16 v[192:207], v[228:231], v[68:71], v[192:207]
  ds_read_b64_tr_b16 v[212:213], v18 offset:10240
  ds_read_b64_tr_b16 v[214:215], v18 offset:10752
  v_mfma_f32_32x32x16_bf16 v[160:175], v[104:107], v[72:75], v[160:175]
  ds_read_b128 v[56:59], v10 offset:0
  ds_read_b64_tr_b16 v[88:89], v18 offset:4096
  ds_read_b64_tr_b16 v[90:91], v18 offset:4608
  v_mfma_f32_32x32x16_bf16 v[176:191], v[136:139], v[72:75], v[176:191]
  ds_read_b64_tr_b16 v[120:121], v16 offset:12288
  ds_read_b64_tr_b16 v[122:123], v16 offset:12800
  v_mfma_f32_32x32x16_bf16 v[192:207], v[232:235], v[72:75], v[192:207]
  ds_read_b64_tr_b16 v[216:217], v18 offset:12288
  ds_read_b64_tr_b16 v[218:219], v18 offset:12800
  v_mfma_f32_32x32x16_bf16 v[160:175], v[108:111], v[76:79], v[160:175]
  ds_read_b128 v[60:63], v11 offset:0
  ds_read_b64_tr_b16 v[92:93], v18 offset:6144
  ds_read_b64_tr_b16 v[94:95], v18 offset:6656
  v_mfma_f32_32x32x16_bf16 v[176:191], v[140:143], v[76:79], v[176:191]
  ds_read_b64_tr_b16 v[124:125], v16 offset:14336
  ds_read_b64_tr_b16 v[126:127], v16 offset:14848
  v_mfma_f32_32x32x16_bf16 v[192:207], v[236:239], v[76:79], v[192:207]
  ds_read_b64_tr_b16 v[220:221], v18 offset:14336
  ds_read_b64_tr_b16 v[222:223], v18 offset:14848
  s_add_u32 m0, s14, 65536
  s_lshl_b32 s11, s81, 7
  buffer_load_dwordx4 v3, s[16:19], s11 offen lds
  s_add_u32 m0, s14, 66560
  s_mul_i32 s12, s81, 229376
  buffer_load_dwordx4 v4, s[16:19], s11 offen lds
  s_add_u32 m0, s15, 81920
  s_add_u32 s81, s81, 1
  buffer_load_dwordx4 v5, s[36:39], s12 offen lds
  s_add_u32 m0, s15, 89984
  s_cmp_ge_u32 s81, 7
  s_cselect_b32 s81, 0, s81
  buffer_load_dwordx4 v5, s[36:39], s12 offen offset:128 lds
  s_add_u32 s10, s8, 0
  s_add_u32 s11, s10, s69
  s_sub_u32 s72, s11, 7
  s_cmp_ge_u32 s11, 7
  s_cselect_b32 s11, s72, s11
  s_cmp_eq_u32 s10, 7
  s_cselect_b32 s11, 64, s11
  s_lshl_b32 s10, s3, 10
  s_add_u32 m0, s10, 131072
  s_mul_i32 s12, s11, 57344
  s_lshl_b32 s11, s11, 7
  buffer_load_dwordx4 v7, s[20:23], s12 offen lds
  buffer_load_ushort v32, v19, s[52:55], s11 offen
  v_add_u32 v18, 49152, v12
  v_xor_b32 v16, 64, v18
  s_waitcnt vmcnt(6)
  s_waitcnt lgkmcnt(0)
  s_barrier
  v_mfma_f32_32x32x16_bf16 v[160:175], v[80:83], v[48:51], v[160:175]
  ds_read_b128 v[64:67], v8 offset:32768
  ds_read_b64_tr_b16 v[96:97], v18 offset:0
  ds_read_b64_tr_b16 v[98:99], v18 offset:512
  v_mfma_f32_32x32x16_bf16 v[176:191], v[112:115], v[48:51], v[176:191]
  ds_read_b64_tr_b16 v[128:129], v16 offset:8192
  ds_read_b64_tr_b16 v[130:131], v16 offset:8704
  v_mfma_f32_32x32x16_bf16 v[192:207], v[208:211], v[48:51], v[192:207]
  ds_read_b64_tr_b16 v[224:225], v18 offset:8192
  ds_read_b64_tr_b16 v[226:227], v18 offset:8704
  v_mfma_f32_32x32x16_bf16 v[160:175], v[84:87], v[52:55], v[160:175]
  ds_read_b128 v[68:71], v9 offset:32768
  ds_read_b64_tr_b16 v[100:101], v18 offset:2048
  ds_read_b64_tr_b16 v[102:103], v18 offset:2560
  v_mfma_f32_32x32x16_bf16 v[176:191], v[116:119], v[52:55], v[176:191]
  ds_read_b64_tr_b16 v[132:133], v16 offset:10240
  ds_read_b64_tr_b16 v[134:135], v16 offset:10752
  v_mfma_f32_32x32x16_bf16 v[192:207], v[212:215], v[52:55], v[192:207]
  ds_read_b64_tr_b16 v[228:229], v18 offset:10240
  ds_read_b64_tr_b16 v[230:231], v18 offset:10752
  v_mfma_f32_32x32x16_bf16 v[160:175], v[88:91], v[56:59], v[160:175]
  ds_read_b128 v[72:75], v10 offset:32768
  ds_read_b64_tr_b16 v[104:105], v18 offset:4096
  ds_read_b64_tr_b16 v[106:107], v18 offset:4608
  v_mfma_f32_32x32x16_bf16 v[176:191], v[120:123], v[56:59], v[176:191]
  ds_read_b64_tr_b16 v[136:137], v16 offset:12288
  ds_read_b64_tr_b16 v[138:139], v16 offset:12800
  v_mfma_f32_32x32x16_bf16 v[192:207], v[216:219], v[56:59], v[192:207]
  ds_read_b64_tr_b16 v[232:233], v18 offset:12288
  ds_read_b64_tr_b16 v[234:235], v18 offset:12800
  v_mfma_f32_32x32x16_bf16 v[160:175], v[92:95], v[60:63], v[160:175]
  ds_read_b128 v[76:79], v11 offset:32768
  ds_read_b64_tr_b16 v[108:109], v18 offset:6144
  ds_read_b64_tr_b16 v[110:111], v18 offset:6656
  v_mfma_f32_32x32x16_bf16 v[176:191], v[124:127], v[60:63], v[176:191]
  ds_read_b64_tr_b16 v[140:141], v16 offset:14336
  ds_read_b64_tr_b16 v[142:143], v16 offset:14848
  v_mfma_f32_32x32x16_bf16 v[192:207], v[220:223], v[60:63], v[192:207]
  ds_read_b64_tr_b16 v[236:237], v18 offset:14336
  ds_read_b64_tr_b16 v[238:239], v18 offset:14848
  s_add_u32 s10, s8, 2
  s_add_u32 s11, s10, s69
  s_sub_u32 s72, s11, 7
  s_cmp_ge_u32 s11, 7
  s_cselect_b32 s11, s72, s11
  s_cmp_eq_u32 s10, 7
  s_cselect_b32 s11, 64, s11
  s_lshl_b32 s10, s3, 10
  s_add_u32 m0, s10, 139264
  s_mul_i32 s12, s11, 57344
  s_lshl_b32 s11, s11, 7
  buffer_load_dwordx4 v7, s[20:23], s12 offen lds
  buffer_load_ushort v34, v19, s[52:55], s11 offen
  s_add_u32 s10, s8, 4
  s_add_u32 s11, s10, s69
  s_sub_u32 s72, s11, 7
  s_cmp_ge_u32 s11, 7
  s_cselect_b32 s11, s72, s11
  s_cmp_eq_u32 s10, 7
  s_cselect_b32 s11, 64, s11
  s_lshl_b32 s10, s3, 10
  s_add_u32 m0, s10, 147456
  s_mul_i32 s12, s11, 57344
  s_lshl_b32 s11, s11, 7
  buffer_load_dwordx4 v7, s[20:23], s12 offen lds
  buffer_load_ushort v36, v19, s[52:55], s11 offen
  v_add_u32 v18, 81920, v12
  v_xor_b32 v16, 64, v18
  v_add_u32 v8, 65536, v8
  v_add_u32 v9, 65536, v9
  v_add_u32 v10, 65536, v10
  v_add_u32 v11, 65536, v11
  s_waitcnt vmcnt(6)
  s_waitcnt lgkmcnt(0)
  s_barrier
  v_mfma_f32_32x32x16_bf16 v[160:175], v[96:99], v[64:67], v[160:175]
  ds_read_b128 v[48:51], v8 offset:0
  ds_read_b64_tr_b16 v[80:81], v18 offset:0
  ds_read_b64_tr_b16 v[82:83], v18 offset:512
  v_mfma_f32_32x32x16_bf16 v[176:191], v[128:131], v[64:67], v[176:191]
  ds_read_b64_tr_b16 v[112:113], v16 offset:8192
  ds_read_b64_tr_b16 v[114:115], v16 offset:8704
  v_mfma_f32_32x32x16_bf16 v[192:207], v[224:227], v[64:67], v[192:207]
  ds_read_b64_tr_b16 v[208:209], v18 offset:8192
  ds_read_b64_tr_b16 v[210:211], v18 offset:8704
  v_mfma_f32_32x32x16_bf16 v[160:175], v[100:103], v[68:71], v[160:175]
  ds_read_b128 v[52:55], v9 offset:0
  ds_read_b64_tr_b16 v[84:85], v18 offset:2048
  ds_read_b64_tr_b16 v[86:87], v18 offset:2560
  v_mfma_f32_32x32x16_bf16 v[176:191], v[132:135], v[68:71], v[176:191]
  ds_read_b64_tr_b16 v[116:117], v16 offset:10240
  ds_read_b64_tr_b16 v[118:119], v16 offset:10752
  v_mfma_f32_32x32x16_bf16 v[192:207], v[228:231], v[68:71], v[192:207]
  ds_read_b64_tr_b16 v[212:213], v18 offset:10240
  ds_read_b64_tr_b16 v[214:215], v18 offset:10752
  v_mfma_f32_32x32x16_bf16 v[160:175], v[104:107], v[72:75], v[160:175]
  ds_read_b128 v[56:59], v10 offset:0
  ds_read_b64_tr_b16 v[88:89], v18 offset:4096
  ds_read_b64_tr_b16 v[90:91], v18 offset:4608
  v_mfma_f32_32x32x16_bf16 v[176:191], v[136:139], v[72:75], v[176:191]
  ds_read_b64_tr_b16 v[120:121], v16 offset:12288
  ds_read_b64_tr_b16 v[122:123], v16 offset:12800
  v_mfma_f32_32x32x16_bf16 v[192:207], v[232:235], v[72:75], v[192:207]
  ds_read_b64_tr_b16 v[216:217], v18 offset:12288
  ds_read_b64_tr_b16 v[218:219], v18 offset:12800
  v_mfma_f32_32x32x16_bf16 v[160:175], v[108:111], v[76:79], v[160:175]
  ds_read_b128 v[60:63], v11 offset:0
  ds_read_b64_tr_b16 v[92:93], v18 offset:6144
  ds_read_b64_tr_b16 v[94:95], v18 offset:6656
  v_mfma_f32_32x32x16_bf16 v[176:191], v[140:143], v[76:79], v[176:191]
  ds_read_b64_tr_b16 v[124:125], v16 offset:14336
  ds_read_b64_tr_b16 v[126:127], v16 offset:14848
  v_mfma_f32_32x32x16_bf16 v[192:207], v[236:239], v[76:79], v[192:207]
  ds_read_b64_tr_b16 v[220:221], v18 offset:14336
  ds_read_b64_tr_b16 v[222:223], v18 offset:14848
  s_add_u32 s10, s8, 6
  s_add_u32 s11, s10, s69
  s_sub_u32 s72, s11, 7
  s_cmp_ge_u32 s11, 7
  s_cselect_b32 s11, s72, s11
  s_cmp_eq_u32 s10, 7
  s_cselect_b32 s11, 64, s11
  s_lshl_b32 s10, s3, 10
  s_add_u32 m0, s10, 155648
  s_mul_i32 s12, s11, 57344
  s_lshl_b32 s11, s11, 7
  buffer_load_dwordx4 v7, s[20:23], s12 offen lds
  buffer_load_ushort v38, v19, s[52:55], s11 offen
  s_lshl_b32 s10, s7, 4
  s_add_u32 s10, s10, s5
  s_lshl_b32 s10, s10, 1
  s_add_u32 s10, s10, s8
  s_lshl_b32 s10, s10, 10
  s_add_u32 s10, s10, s68
  s_add_u32 s10, s10, 524288
  v_mov_b32 v40, -1
  v_mov_b32 v41, -1
  v_mov_b32 v42, -1
  v_mov_b32 v43, -1
  buffer_store_dwordx4 v[40:43], v2, s[64:67], s10 offen sc1
  buffer_load_dwordx2 v[24:25], v15, s[60:63], 0 offen sc1
  s_waitcnt lgkmcnt(0)
  v_mfma_f32_32x32x16_bf16 v[160:175], v[80:83], v[48:51], v[160:175]
  v_mfma_f32_32x32x16_bf16 v[176:191], v[112:115], v[48:51], v[176:191]
  v_mfma_f32_32x32x16_bf16 v[192:207], v[208:211], v[48:51], v[192:207]
  v_mfma_f32_32x32x16_bf16 v[160:175], v[84:87], v[52:55], v[160:175]
  v_mfma_f32_32x32x16_bf16 v[176:191], v[116:119], v[52:55], v[176:191]
  v_mfma_f32_32x32x16_bf16 v[192:207], v[212:215], v[52:55], v[192:207]
  v_mfma_f32_32x32x16_bf16 v[160:175], v[88:91], v[56:59], v[160:175]
  v_mfma_f32_32x32x16_bf16 v[176:191], v[120:123], v[56:59], v[176:191]
  v_mfma_f32_32x32x16_bf16 v[192:207], v[216:219], v[56:59], v[192:207]
  v_mfma_f32_32x32x16_bf16 v[160:175], v[92:95], v[60:63], v[160:175]
  v_mfma_f32_32x32x16_bf16 v[176:191], v[124:127], v[60:63], v[176:191]
  v_mfma_f32_32x32x16_bf16 v[192:207], v[220:223], v[60:63], v[192:207]
  buffer_load_dwordx2 v[26:27], v23, s[64:67], s13 offen sc1
  s_nop 8
  v_pk_mul_f32 v[80:81], v[160:161], v[160:161]
  v_pk_mul_f32 v[82:83], v[162:163], v[162:163]
  v_pk_mul_f32 v[84:85], v[164:165], v[164:165]
  v_pk_mul_f32 v[86:87], v[166:167], v[166:167]
  v_pk_mul_f32 v[88:89], v[168:169], v[168:169]
  v_pk_mul_f32 v[90:91], v[170:171], v[170:171]
  v_pk_mul_f32 v[92:93], v[172:173], v[172:173]
  v_pk_mul_f32 v[94:95], v[174:175], v[174:175]
  v_pk_fma_f32 v[80:81], v[80:81], s[70:71], v[30:31]
  v_pk_fma_f32 v[82:83], v[82:83], s[70:71], v[30:31]
  v_pk_fma_f32 v[84:85], v[84:85], s[70:71], v[30:31]
  v_pk_fma_f32 v[86:87], v[86:87], s[70:71], v[30:31]
  v_pk_fma_f32 v[88:89], v[88:89], s[70:71], v[30:31]
  v_pk_fma_f32 v[90:91], v[90:91], s[70:71], v[30:31]
  v_pk_fma_f32 v[92:93], v[92:93], s[70:71], v[30:31]
  v_pk_fma_f32 v[94:95], v[94:95], s[70:71], v[30:31]
  v_pk_mul_f32 v[80:81], v[80:81], v[160:161]
  v_pk_mul_f32 v[82:83], v[82:83], v[162:163]
  v_pk_mul_f32 v[84:85], v[84:85], v[164:165]
  v_pk_mul_f32 v[86:87], v[86:87], v[166:167]
  v_pk_mul_f32 v[88:89], v[88:89], v[168:169]
  v_pk_mul_f32 v[90:91], v[90:91], v[170:171]
  v_pk_mul_f32 v[92:93], v[92:93], v[172:173]
  v_pk_mul_f32 v[94:95], v[94:95], v[174:175]
  v_exp_f32 v80, v80
  v_exp_f32 v81, v81
  v_exp_f32 v82, v82
  v_exp_f32 v83, v83
  v_exp_f32 v84, v84
  v_exp_f32 v85, v85
  v_exp_f32 v86, v86
  v_exp_f32 v87, v87
  v_exp_f32 v88, v88
  v_exp_f32 v89, v89
  v_exp_f32 v90, v90
  v_exp_f32 v91, v91
  v_exp_f32 v92, v92
  v_exp_f32 v93, v93
  v_exp_f32 v94, v94
  v_exp_f32 v95, v95
  v_pk_add_f32 v[80:81], v[80:81], 1.0 op_sel_hi:[1,0]
  v_pk_add_f32 v[82:83], v[82:83], 1.0 op_sel_hi:[1,0]
  v_pk_add_f32 v[84:85], v[84:85], 1.0 op_sel_hi:[1,0]
  v_pk_add_f32 v[86:87], v[86:87], 1.0 op_sel_hi:[1,0]
  v_pk_add_f32 v[88:89], v[88:89], 1.0 op_sel_hi:[1,0]
  v_pk_add_f32 v[90:91], v[90:91], 1.0 op_sel_hi:[1,0]
  v_pk_add_f32 v[92:93], v[92:93], 1.0 op_sel_hi:[1,0]
  v_pk_add_f32 v[94:95], v[94:95], 1.0 op_sel_hi:[1,0]
  v_rcp_f32 v80, v80
  v_rcp_f32 v81, v81
  v_rcp_f32 v82, v82
  v_rcp_f32 v83, v83
  v_rcp_f32 v84, v84
  v_rcp_f32 v85, v85
  v_rcp_f32 v86, v86
  v_rcp_f32 v87, v87
  v_rcp_f32 v88, v88
  v_rcp_f32 v89, v89
  v_rcp_f32 v90, v90
  v_rcp_f32 v91, v91
  v_rcp_f32 v92, v92
  v_rcp_f32 v93, v93
  v_rcp_f32 v94, v94
  v_rcp_f32 v95, v95
  v_pk_mul_f32 v[80:81], v[80:81], v[160:161]
  v_pk_mul_f32 v[82:83], v[82:83], v[162:163]
  v_pk_mul_f32 v[84:85], v[84:85], v[164:165]
  v_pk_mul_f32 v[86:87], v[86:87], v[166:167]
  v_pk_mul_f32 v[88:89], v[88:89], v[168:169]
  v_pk_mul_f32 v[90:91], v[90:91], v[170:171]
  v_pk_mul_f32 v[92:93], v[92:93], v[172:173]
  v_pk_mul_f32 v[94:95], v[94:95], v[174:175]
  v_cvt_pk_bf16_f32 v160, v80, v81
  v_cvt_pk_bf16_f32 v161, v82, v83
  v_cvt_pk_bf16_f32 v162, v84, v85
  v_cvt_pk_bf16_f32 v163, v86, v87
  v_cvt_pk_bf16_f32 v164, v88, v89
  v_cvt_pk_bf16_f32 v165, v90, v91
  v_cvt_pk_bf16_f32 v166, v92, v93
  v_cvt_pk_bf16_f32 v167, v94, v95
  s_waitcnt vmcnt(1)
  ds_write_b64 v14, v[32:33] offset:0
  ds_write_b64 v14, v[34:35] offset:8192
  ds_write_b64 v14, v[36:37] offset:16384
  ds_write_b64 v14, v[38:39] offset:24576
  s_waitcnt vmcnt(0)
  s_mov_b32 s80, 0
tok3:
  v_cmp_ne_u32 vcc, 0, v24
  s_nop 1
  s_cbranch_vccnz tok3_ok
  s_sleep 1
  buffer_load_dwordx2 v[24:25], v15, s[60:63], 0 offen sc1
  s_waitcnt vmcnt(0)
  s_add_u32 s80, s80, 1
  s_cmp_lt_u32 s80, 20000000
  s_cbranch_scc1 tok3
tok3_ok:
  s_cmp_lg_u32 s3, 7
  s_cbranch_scc1 poll4_ok
  s_mov_b32 s72, 0xffffffff
  s_mov_b32 s73, 0x0
  s_mov_b32 s80, 0
poll4:
  v_cmp_eq_u64 vcc, v[26:27], v[24:25]
  s_nop 1
  s_and_b64 vcc, vcc, s[72:73]
  s_cmp_eq_u64 vcc, s[72:73]
  s_cbranch_scc1 poll4_ok
  s_sleep 1
  buffer_load_dwordx2 v[26:27], v23, s[64:67], s13 offen sc1
  s_waitcnt vmcnt(0)
  s_add_u32 s80, s80, 1
  s_cmp_lt_u32 s80, 20000000
  s_cbranch_scc1 poll4
poll4_ok:
  s_waitcnt lgkmcnt(0)
  s_barrier
  s_add_u32 s81, s5, 0
  s_and_b32 s81, s81, 7
  s_lshl_b32 s81, s81, 15
  s_add_u32 s81, s81, s85
  s_add_u32 m0, s85, 0
  s_nop 0
  buffer_load_dwordx4 v2, s[64:67], s81 offen offset:0 sc1 lds
  buffer_load_dwordx4 v2, s[64:67], s81 offen offset:1024 sc1 lds
  buffer_load_dwordx4 v2, s[64:67], s81 offen offset:2048 sc1 lds
  buffer_load_dwordx4 v2, s[64:67], s81 offen offset:3072 sc1 lds
  s_add_u32 m0, s85, 4096
  s_add_u32 s81, s81, 4096
  buffer_load_dwordx4 v2, s[64:67], s81 offen offset:0 sc1 lds
  buffer_load_dwordx4 v2, s[64:67], s81 offen offset:1024 sc1 lds
  buffer_load_dwordx4 v2, s[64:67], s81 offen offset:2048 sc1 lds
  buffer_load_dwordx4 v2, s[64:67], s81 offen offset:3072 sc1 lds
  buffer_store_dwordx4 v[160:163], v2, s[64:67], s76 offen offset:2048 sc1
  buffer_store_dwordx4 v[164:167], v2, s[64:67], s76 offen offset:3072 sc1
  v_mul_f32 v80, v176, v176
  v_mul_f32 v81, v177, v177
  v_mul_f32 v82, v178, v178
  v_mul_f32 v83, v179, v179
  v_mul_f32 v84, v180, v180
  v_mul_f32 v85, v181, v181
  v_mul_f32 v86, v182, v182
  v_mul_f32 v87, v183, v183
  v_mul_f32 v88, v184, v184
  v_mul_f32 v89, v185, v185
  v_mul_f32 v90, v186, v186
  v_mul_f32 v91, v187, v187
  v_mul_f32 v92, v188, v188
  v_mul_f32 v93, v189, v189
  v_mul_f32 v94, v190, v190
  v_mul_f32 v95, v191, v191
  v_fmaak_f32 v80, v80, v29, 0xc0135761
  v_fmaak_f32 v81, v81, v29, 0xc0135761
  v_fmaak_f32 v82, v82, v29, 0xc0135761
  v_fmaak_f32 v83, v83, v29, 0xc0135761
  v_fmaak_f32 v84, v84, v29, 0xc0135761
  v_fmaak_f32 v85, v85, v29, 0xc0135761
  v_fmaak_f32 v86, v86, v29, 0xc0135761
  v_fmaak_f32 v87, v87, v29, 0xc0135761
  v_fmaak_f32 v88, v88, v29, 0xc0135761
  v_fmaak_f32 v89, v89, v29, 0xc0135761
  v_fmaak_f32 v90, v90, v29, 0xc0135761
  v_fmaak_f32 v91, v91, v29, 0xc0135761
  v_fmaak_f32 v92, v92, v29, 0xc0135761
  v_fmaak_f32 v93, v93, v29, 0xc0135761
  v_fmaak_f32 v94, v94, v29, 0xc0135761
  v_fmaak_f32 v95, v95, v29, 0xc0135761
  v_mul_f32 v80, v80, v176
  v_mul_f32 v81, v81, v177
  v_mul_f32 v82, v82, v178
  v_mul_f32 v83, v83, v179
  v_mul_f32 v84, v84, v180
  v_mul_f32 v85, v85, v181
  v_mul_f32 v86, v86, v182
  v_mul_f32 v87, v87, v183
  v_mul_f32 v88, v88, v184
  v_mul_f32 v89, v89, v185
  v_mul_f32 v90, v90, v186
  v_mul_f32 v91, v91, v187
  v_mul_f32 v92, v92, v188
  v_mul_f32 v93, v93, v189
  v_mul_f32 v94, v94, v190
  v_mul_f32 v95, v95, v191
  v_exp_f32 v80, v80
  v_exp_f32 v81, v81
  v_exp_f32 v82, v82
  v_exp_f32 v83, v83
  v_exp_f32 v84, v84
  v_exp_f32 v85, v85
  v_exp_f32 v86, v86
  v_exp_f32 v87, v87
  v_exp_f32 v88, v88
  v_exp_f32 v89, v89
  v_exp_f32 v90, v90
  v_exp_f32 v91, v91
  v_exp_f32 v92, v92
  v_exp_f32 v93, v93
  v_exp_f32 v94, v94
  v_exp_f32 v95, v95
  v_add_f32 v80, 1.0, v80
  v_add_f32 v81, 1.0, v81
  v_add_f32 v82, 1.0, v82
  v_add_f32 v83, 1.0, v83
  v_add_f32 v84, 1.0, v84
  v_add_f32 v85, 1.0, v85
  v_add_f32 v86, 1.0, v86
  v_add_f32 v87, 1.0, v87
  v_add_f32 v88, 1.0, v88
  v_add_f32 v89, 1.0, v89
  v_add_f32 v90, 1.0, v90
  v_add_f32 v91, 1.0, v91
  v_add_f32 v92, 1.0, v92
  v_add_f32 v93, 1.0, v93
  v_add_f32 v94, 1.0, v94
  v_add_f32 v95, 1.0, v95
  v_rcp_f32 v80, v80
  v_rcp_f32 v81, v81
  v_rcp_f32 v82, v82
  v_rcp_f32 v83, v83
  v_rcp_f32 v84, v84
  v_rcp_f32 v85, v85
  v_rcp_f32 v86, v86
  v_rcp_f32 v87, v87
  v_rcp_f32 v88, v88
  v_rcp_f32 v89, v89
  v_rcp_f32 v90, v90
  v_rcp_f32 v91, v91
  v_rcp_f32 v92, v92
  v_rcp_f32 v93, v93
  v_rcp_f32 v94, v94
  v_rcp_f32 v95, v95
  v_mul_f32 v80, v80, v176
  v_mul_f32 v81, v81, v177
  v_mul_f32 v82, v82, v178
  v_mul_f32 v83, v83, v179
  v_mul_f32 v84, v84, v180
  v_mul_f32 v85, v85, v181
  v_mul_f32 v86, v86, v182
  v_mul_f32 v87, v87, v183
  v_mul_f32 v88, v88, v184
  v_mul_f32 v89, v89, v185
  v_mul_f32 v90, v90, v186
  v_mul_f32 v91, v91, v187
  v_mul_f32 v92, v92, v188
  v_mul_f32 v93, v93, v189
  v_mul_f32 v94, v94, v190
  v_mul_f32 v95, v95, v191
  v_cvt_pk_bf16_f32 v176, v80, v81
  v_cvt_pk_bf16_f32 v177, v82, v83
  v_cvt_pk_bf16_f32 v178, v84, v85
  v_cvt_pk_bf16_f32 v179, v86, v87
  v_cvt_pk_bf16_f32 v180, v88, v89
  v_cvt_pk_bf16_f32 v181, v90, v91
  v_cvt_pk_bf16_f32 v182, v92, v93
  v_cvt_pk_bf16_f32 v183, v94, v95
  buffer_store_dwordx4 v[176:179], v2, s[64:67], s77 offen offset:0 sc1
  buffer_store_dwordx4 v[180:183], v2, s[64:67], s77 offen offset:1024 sc1
  v_mul_f32 v80, v192, v192
  v_mul_f32 v81, v193, v193
  v_mul_f32 v82, v194, v194
  v_mul_f32 v83, v195, v195
  v_mul_f32 v84, v196, v196
  v_mul_f32 v85, v197, v197
  v_mul_f32 v86, v198, v198
  v_mul_f32 v87, v199, v199
  v_mul_f32 v88, v200, v200
  v_mul_f32 v89, v201, v201
  v_mul_f32 v90, v202, v202
  v_mul_f32 v91, v203, v203
  v_mul_f32 v92, v204, v204
  v_mul_f32 v93, v205, v205
  v_mul_f32 v94, v206, v206
  v_mul_f32 v95, v207, v207
  v_fmaak_f32 v80, v80, v29, 0xc0135761
  v_fmaak_f32 v81, v81, v29, 0xc0135761
  v_fmaak_f32 v82, v82, v29, 0xc0135761
  v_fmaak_f32 v83, v83, v29, 0xc0135761
  v_fmaak_f32 v84, v84, v29, 0xc0135761
  v_fmaak_f32 v85, v85, v29, 0xc0135761
  v_fmaak_f32 v86, v86, v29, 0xc0135761
  v_fmaak_f32 v87, v87, v29, 0xc0135761
  v_fmaak_f32 v88, v88, v29, 0xc0135761
  v_fmaak_f32 v89, v89, v29, 0xc0135761
  v_fmaak_f32 v90, v90, v29, 0xc0135761
  v_fmaak_f32 v91, v91, v29, 0xc0135761
  v_fmaak_f32 v92, v92, v29, 0xc0135761
  v_fmaak_f32 v93, v93, v29, 0xc0135761
  v_fmaak_f32 v94, v94, v29, 0xc0135761
  v_fmaak_f32 v95, v95, v29, 0xc0135761
  v_mul_f32 v80, v80, v192
  v_mul_f32 v81, v81, v193
  v_mul_f32 v82, v82, v194
  v_mul_f32 v83, v83, v195
  v_mul_f32 v84, v84, v196
  v_mul_f32 v85, v85, v197
  v_mul_f32 v86, v86, v198
  v_mul_f32 v87, v87, v199
  v_mul_f32 v88, v88, v200
  v_mul_f32 v89, v89, v201
  v_mul_f32 v90, v90, v202
  v_mul_f32 v91, v91, v203
  v_mul_f32 v92, v92, v204
  v_mul_f32 v93, v93, v205
  v_mul_f32 v94, v94, v206
  v_mul_f32 v95, v95, v207
  v_exp_f32 v80, v80
  v_exp_f32 v81, v81
  v_exp_f32 v82, v82
  v_exp_f32 v83, v83
  v_exp_f32 v84, v84
  v_exp_f32 v85, v85
  v_exp_f32 v86, v86
  v_exp_f32 v87, v87
  v_exp_f32 v88, v88
  v_exp_f32 v89, v89
  v_exp_f32 v90, v90
  v_exp_f32 v91, v91
  v_exp_f32 v92, v92
  v_exp_f32 v93, v93
  v_exp_f32 v94, v94
  v_exp_f32 v95, v95
  v_add_f32 v80, 1.0, v80
  v_add_f32 v81, 1.0, v81
  v_add_f32 v82, 1.0, v82
  v_add_f32 v83, 1.0, v83
  v_add_f32 v84, 1.0, v84
  v_add_f32 v85, 1.0, v85
  v_add_f32 v86, 1.0, v86
  v_add_f32 v87, 1.0, v87
  v_add_f32 v88, 1.0, v88
  v_add_f32 v89, 1.0, v89
  v_add_f32 v90, 1.0, v90
  v_add_f32 v91, 1.0, v91
  v_add_f32 v92, 1.0, v92
  v_add_f32 v93, 1.0, v93
  v_add_f32 v94, 1.0, v94
  v_add_f32 v95, 1.0, v95
  v_rcp_f32 v80, v80
  v_rcp_f32 v81, v81
  v_rcp_f32 v82, v82
  v_rcp_f32 v83, v83
  v_rcp_f32 v84, v84
  v_rcp_f32 v85, v85
  v_rcp_f32 v86, v86
  v_rcp_f32 v87, v87
  v_rcp_f32 v88, v88
  v_rcp_f32 v89, v89
  v_rcp_f32 v90, v90
  v_rcp_f32 v91, v91
  v_rcp_f32 v92, v92
  v_rcp_f32 v93, v93
  v_rcp_f32 v94, v94
  v_rcp_f32 v95, v95
  v_mul_f32 v80, v80, v192
  v_mul_f32 v81, v81, v193
  v_mul_f32 v82, v82, v194
  v_mul_f32 v83, v83, v195
  v_mul_f32 v84, v84, v196
  v_mul_f32 v85, v85, v197
  v_mul_f32 v86, v86, v198
  v_mul_f32 v87, v87, v199
  v_mul_f32 v88, v88, v200
  v_mul_f32 v89, v89, v201
  v_mul_f32 v90, v90, v202
  v_mul_f32 v91, v91, v203
  v_mul_f32 v92, v92, v204
  v_mul_f32 v93, v93, v205
  v_mul_f32 v94, v94, v206
  v_mul_f32 v95, v95, v207
  v_cvt_pk_bf16_f32 v192, v80, v81
  v_cvt_pk_bf16_f32 v193, v82, v83
  v_cvt_pk_bf16_f32 v194, v84, v85
  v_cvt_pk_bf16_f32 v195, v86, v87
  v_cvt_pk_bf16_f32 v196, v88, v89
  v_cvt_pk_bf16_f32 v197, v90, v91
  v_cvt_pk_bf16_f32 v198, v92, v93
  v_cvt_pk_bf16_f32 v199, v94, v95
  buffer_store_dwordx4 v[192:195], v2, s[64:67], s77 offen offset:2048 sc1
  buffer_store_dwordx4 v[196:199], v2, s[64:67], s77 offen offset:3072 sc1
  s_lshl_b32 s10, s82, 1
  s_and_b32 s11, s3, 1
  s_add_u32 s76, s10, s11
  s_lshl_b32 s10, s76, 8
  s_add_u32 s10, s10, 110592
  v_lshl_add_u32 v16, v1, 2, s10
  s_waitcnt vmcnt(6)
  s_waitcnt lgkmcnt(0)
  s_barrier
  s_branch L_serv
L_kv:
  s_mov_b32 s69, 0
  s_lshl_b32 s10, s4, 7
  s_lshl_b32 s11, s82, 6
  s_add_u32 s10, s10, s11
  s_lshl_b32 s11, s3, 3
  s_add_u32 s10, s10, s11
  v_add_u32 v117, s10, v112
  v_mul_u32_u24 v117, 896, v117
  s_and_b32 s11, s3, 1
  s_lshl_b32 s11, s11, 2
  v_xor_b32 v115, s11, v115
  v_lshl_add_u32 v3, v115, 4, v117
  s_mov_b32 s12, 57344
  s_cmp_eq_u32 s82, 0
  s_cselect_b32 s11, s12, 0xffff2000
  v_add_u32 v4, s11, v3
  s_lshl_b32 s15, s3, 10
  s_waitcnt lgkmcnt(0)
  s_add_u32 m0, s15, 0
  s_mov_b32 s11, 0
  buffer_load_dwordx4 v3, s[16:19], s11 offen lds
  s_add_u32 m0, s15, 57344
  s_add_u32 s11, s15, 0
  buffer_load_dwordx4 v2, s[24:27], s11 offen lds
  s_add_u32 m0, s15, 82944
  s_add_u32 s11, s15, 0
  buffer_load_dwordx4 v2, s[28:31], s11 offen lds
  s_add_u32 m0, s15, 8192
  s_mov_b32 s11, 128
  buffer_load_dwordx4 v3, s[16:19], s11 offen lds
  s_add_u32 m0, s15, 16384
  s_mov_b32 s11, 256
  buffer_load_dwordx4 v3, s[16:19], s11 offen lds
  s_add_u32 m0, s15, 65536
  s_add_u32 s11, s15, 8192
  buffer_load_dwordx4 v2, s[24:27], s11 offen lds
  s_add_u32 m0, s15, 91136
  s_add_u32 s11, s15, 8192
  buffer_load_dwordx4 v2, s[28:31], s11 offen lds
  s_add_u32 m0, s15, 24576
  s_mov_b32 s11, 384
  buffer_load_dwordx4 v3, s[16:19], s11 offen lds
  s_add_u32 m0, s15, 32768
  s_mov_b32 s11, 512
  buffer_load_dwordx4 v3, s[16:19], s11 offen lds
  s_add_u32 m0, s15, 73728
  s_add_u32 s11, s15, 16384
  buffer_load_dwordx4 v2, s[24:27], s11 offen lds
  s_add_u32 m0, s15, 99328
  s_add_u32 s11, s15, 16384
  buffer_load_dwordx4 v2, s[28:31], s11 offen lds
  s_add_u32 m0, s15, 40960
  s_mov_b32 s11, 640
  buffer_load_dwordx4 v3, s[16:19], s11 offen lds
  s_add_u32 m0, s15, 49152
  s_mov_b32 s11, 768
  buffer_load_dwordx4 v3, s[16:19], s11 offen lds
  s_cmp_lg_u32 s3, 0
  s_cbranch_scc1 L_kv_np
  s_mov_b32 m0, 81920
  s_mov_b32 s11, 24576
  buffer_load_dwordx4 v2, s[24:27], s11 offen lds
  s_mov_b32 m0, 107520
  s_mov_b32 s11, 24576
  buffer_load_dwordx4 v2, s[28:31], s11 offen lds
L_kv_np:
  s_load_dwordx2 s[20:21], s[0:1], 8
  s_load_dwordx2 s[52:53], s[0:1], 80
  s_load_dwordx2 s[64:65], s[0:1], 104
  s_load_dwordx2 s[32:33], s[0:1], 32
  s_load_dwordx2 s[44:45], s[0:1], 64
  s_load_dwordx2 s[48:49], s[0:1], 72
  s_load_dwordx2 s[56:57], s[0:1], 88
  s_mov_b32 s22, 401408
  s_mov_b32 s23, 0x00020000
  s_mov_b32 s54, 896
  s_mov_b32 s55, 0x00020000
  s_mov_b32 s66, 37748736
  s_mov_b32 s67, 0x00020000
  s_mov_b32 s34, 401408
  s_mov_b32 s35, 0x00020000
  s_mov_b32 s46, 1605632
  s_mov_b32 s47, 0x00020000
  s_mov_b32 s50, 896
  s_mov_b32 s51, 0x00020000
  s_mov_b32 s58, 1835008
  s_mov_b32 s59, 0x00020000
  s_mov_b32 s10, 0x65432710
  s_mov_b32 s11, 0x65432170
  s_lshl_b32 s12, s5, 2
  s_lshr_b64 s[10:11], s[10:11], s12
  s_and_b32 s9, s10, 15
  s_and_b32 s7, s3, 3
  s_lshr_b32 s8, s3, 2
  s_add_u32 s68, s4, 1
  s_lshl_b32 s68, s68, 21
  v_mov_b32 v15, 0
  v_lshlrev_b32 v23, 3, v1
  v_mul_u32_u24 v117, 896, v112
  v_lshl_add_u32 v117, v116, 4, v117
  s_lshl_b32 s11, s9, 7
  v_add_u32 v22, s11, v117
  v_lshrrev_b32 v117, 2, v1
  s_lshl_b32 s11, s7, 4
  v_add_u32 v117, s11, v117
  v_mul_u32_u24 v118, 896, v117
  v_and_b32 v119, 3, v1
  v_lshl_add_u32 v118, v119, 4, v118
  s_mul_i32 s12, s5, 56
  v_add_u32 v7, s12, v118
  v_and_b32 v118, 15, v1
  v_add_lshl_u32 v19, s11, v118, 1
  s_lshl_b32 s12, s3, 10
  s_add_u32 s12, s12, 65592
  v_lshl_add_u32 v14, v118, 6, s12
  v_add_u32 v14, 65536, v14
  v_mov_b32 v33, 0
  v_mov_b32 v35, 0
  v_mov_b32 v37, 0
  v_mov_b32 v39, 0
  v_and_b32 v117, 31, v1
  v_lshrrev_b32 v118, 5, v1
  v_bfe_u32 v121, v1, 2, 2
  v_lshl_add_u32 v122, v118, 3, v121
  v_and_b32 v123, 1, v114
  v_bfe_u32 v124, v1, 1, 1
  v_lshl_add_u32 v124, v123, 1, v124
  v_lshrrev_b32 v125, 1, v121
  v_and_b32 v127, 1, v1
  v_lshlrev_b32 v127, 3, v127
  v_xor_b32 v126, s8, v125
  v_lshl_add_u32 v126, v126, 2, v124
  v_lshl_add_u32 v126, v126, 4, v127
  v_lshl_add_u32 v12, v122, 7, v126
  v_lshl_add_u32 v128, v118, 2, v121
  v_lshl_add_u32 v126, v125, 2, v124
  v_lshl_add_u32 v126, v126, 4, v127
  v_lshl_add_u32 v21, v128, 7, v126
  s_lshr_b32 s11, s3, 1
  s_lshl_b32 s11, s11, 12
  v_add_u32 v21, s11, v21
  v_xor_b32 v20, 64, v21
  v_lshlrev_b32 v125, 6, v122
  v_lshl_add_u32 v125, v123, 5, v125
  v_and_b32 v126, 3, v1
  v_lshl_add_u32 v13, v126, 3, v125
  v_add_u32 v13, 131072, v13
  s_mov_b32 s70, 0xbdd2d3e8
  s_mov_b32 s71, 0xbdd2d3e8
  v_mov_b32 v30, 0xc0135761
  v_mov_b32 v31, 0xc0135761
  v_mov_b32 v29, 0xbdd2d3e8
  s_and_b32 s11, s3, 1
  s_lshl_b32 s11, s11, 5
  v_add_u32 v130, s11, v117
  v_bfe_u32 v119, v130, 1, 3
  v_xor_b32 v119, v119, v118
  v_lshlrev_b32 v129, 7, v130
  v_xor_b32 v121, 0, v119
  v_lshl_add_u32 v8, v121, 4, v129
  v_xor_b32 v121, 2, v119
  v_lshl_add_u32 v9, v121, 4, v129
  v_xor_b32 v121, 4, v119
  v_lshl_add_u32 v10, v121, 4, v129
  v_xor_b32 v121, 6, v119
  v_lshl_add_u32 v11, v121, 4, v129
  v_mul_u32_u24 v125, 56, v122
  v_lshl_add_u32 v125, v123, 5, v125
  v_and_b32 v126, 3, v1
  v_lshl_add_u32 v125, v126, 3, v125
  s_mov_b32 s12, 82944
  s_bitcmp1_b32 s3, 1
  s_cselect_b32 s11, s12, 57344
  v_add_u32 v18, s11, v125
  s_waitcnt lgkmcnt(0)
  buffer_load_dwordx2 v[24:25], v15, s[60:63], 0 offen sc1
  s_waitcnt vmcnt(6)
  s_barrier
  s_cmp_ge_u32 s3, 4
  s_cbranch_scc1 L_kv_idle
  s_cmp_ge_u32 s3, 2
  s_cbranch_scc1 L_kv_V
  ds_read_b128 v[48:51], v8 offset:0
  ds_read_b64_tr_b16 v[208:209], v18 offset:0
  ds_read_b64_tr_b16 v[210:211], v18 offset:224
  ds_read_b128 v[52:55], v9 offset:0
  ds_read_b64_tr_b16 v[212:213], v18 offset:896
  ds_read_b64_tr_b16 v[214:215], v18 offset:1120
  ds_read_b128 v[56:59], v10 offset:0
  ds_read_b64_tr_b16 v[216:217], v18 offset:1792
  ds_read_b64_tr_b16 v[218:219], v18 offset:2016
  ds_read_b128 v[60:63], v11 offset:0
  ds_read_b64_tr_b16 v[220:221], v18 offset:2688
  ds_read_b64_tr_b16 v[222:223], v18 offset:2912
  ds_read_b128 v[64:67], v8 offset:8192
  ds_read_b64_tr_b16 v[224:225], v18 offset:3584
  ds_read_b64_tr_b16 v[226:227], v18 offset:3808
  s_waitcnt lgkmcnt(12)
  v_mfma_f32_32x32x16_bf16 v[160:175], v[208:211], v[48:51], 0
  ds_read_b128 v[68:71], v9 offset:8192
  ds_read_b64_tr_b16 v[228:229], v18 offset:4480
  ds_read_b64_tr_b16 v[230:231], v18 offset:4704
  s_waitcnt lgkmcnt(12)
  v_mfma_f32_32x32x16_bf16 v[160:175], v[212:215], v[52:55], v[160:175]
  ds_read_b128 v[72:75], v10 offset:8192
  ds_read_b64_tr_b16 v[232:233], v18 offset:5376
  ds_read_b64_tr_b16 v[234:235], v18 offset:5600
  s_waitcnt lgkmcnt(12)
  v_mfma_f32_32x32x16_bf16 v[160:175], v[216:219], v[56:59], v[160:175]
  ds_read_b128 v[76:79], v11 offset:8192
  ds_read_b64_tr_b16 v[236:237], v18 offset:6272
  ds_read_b64_tr_b16 v[238:239], v18 offset:6496
  s_waitcnt lgkmcnt(12)
  v_mfma_f32_32x32x16_bf16 v[160:175], v[220:223], v[60:63], v[160:175]
  ds_read_b128 v[80:83], v8 offset:16384
  ds_read_b64_tr_b16 v[208:209], v18 offset:7168
  ds_read_b64_tr_b16 v[210:211], v18 offset:7392
  s_waitcnt lgkmcnt(12)
  v_mfma_f32_32x32x16_bf16 v[160:175], v[224:227], v[64:67], v[160:175]
  ds_read_b128 v[84:87], v9 offset:16384
  ds_read_b64_tr_b16 v[212:213], v18 offset:8064
  ds_read_b64_tr_b16 v[214:215], v18 offset:8288
  s_waitcnt lgkmcnt(12)
  v_mfma_f32_32x32x16_bf16 v[160:175], v[228:231], v[68:71], v[160:175]
  ds_read_b128 v[88:91], v10 offset:16384
  ds_read_b64_tr_b16 v[216:217], v18 offset:8960
  ds_read_b64_tr_b16 v[218:219], v18 offset:9184
  s_waitcnt lgkmcnt(12)
  v_mfma_f32_32x32x16_bf16 v[160:175], v[232:235], v[72:75], v[160:175]
  ds_read_b128 v[92:95], v11 offset:16384
  ds_read_b64_tr_b16 v[220:221], v18 offset:9856
  ds_read_b64_tr_b16 v[222:223], v18 offset:10080
  s_waitcnt lgkmcnt(12)
  v_mfma_f32_32x32x16_bf16 v[160:175], v[236:239], v[76:79], v[160:175]
  ds_read_b128 v[96:99], v8 offset:24576
  ds_read_b64_tr_b16 v[224:225], v18 offset:10752
  ds_read_b64_tr_b16 v[226:227], v18 offset:10976
  s_waitcnt lgkmcnt(12)
  v_mfma_f32_32x32x16_bf16 v[160:175], v[208:211], v[80:83], v[160:175]
  ds_read_b128 v[100:103], v9 offset:24576
  ds_read_b64_tr_b16 v[228:229], v18 offset:11648
  ds_read_b64_tr_b16 v[230:231], v18 offset:11872
  s_waitcnt lgkmcnt(12)
  v_mfma_f32_32x32x16_bf16 v[160:175], v[212:215], v[84:87], v[160:175]
  ds_read_b128 v[104:107], v10 offset:24576
  ds_read_b64_tr_b16 v[232:233], v18 offset:12544
  ds_read_b64_tr_b16 v[234:235], v18 offset:12768
  s_waitcnt lgkmcnt(12)
  v_mfma_f32_32x32x16_bf16 v[160:175], v[216:219], v[88:91], v[160:175]
  ds_read_b128 v[108:111], v11 offset:24576
  ds_read_b64_tr_b16 v[236:237], v18 offset:13440
  ds_read_b64_tr_b16 v[238:239], v18 offset:13664
  s_waitcnt lgkmcnt(12)
  v_mfma_f32_32x32x16_bf16 v[160:175], v[220:223], v[92:95], v[160:175]
  s_waitcnt lgkmcnt(9)
  v_mfma_f32_32x32x16_bf16 v[160:175], v[224:227], v[96:99], v[160:175]
  s_waitcnt lgkmcnt(6)
  v_mfma_f32_32x32x16_bf16 v[160:175], v[228:231], v[100:103], v[160:175]
  s_waitcnt lgkmcnt(3)
  v_mfma_f32_32x32x16_bf16 v[160:175], v[232:235], v[104:107], v[160:175]
  s_waitcnt lgkmcnt(0)
  v_mfma_f32_32x32x16_bf16 v[160:175], v[236:239], v[108:111], v[160:175]
  s_waitcnt vmcnt(0)
  s_barrier
  ds_read_b128 v[112:115], v8 offset:32768
  ds_read_b64_tr_b16 v[208:209], v18 offset:14336
  ds_read_b64_tr_b16 v[210:211], v18 offset:14560
  ds_read_b128 v[116:119], v9 offset:32768
  ds_read_b64_tr_b16 v[212:213], v18 offset:15232
  ds_read_b64_tr_b16 v[214:215], v18 offset:15456
  ds_read_b128 v[120:123], v10 offset:32768
  ds_read_b64_tr_b16 v[216:217], v18 offset:16128
  ds_read_b64_tr_b16 v[218:219], v18 offset:16352
  ds_read_b128 v[124:127], v11 offset:32768
  ds_read_b64_tr_b16 v[220:221], v18 offset:17024
  ds_read_b64_tr_b16 v[222:223], v18 offset:17248
  ds_read_b128 v[128:131], v8 offset:40960
  ds_read_b64_tr_b16 v[224:225], v18 offset:17920
  ds_read_b64_tr_b16 v[226:227], v18 offset:18144
  s_waitcnt lgkmcnt(12)
  v_mfma_f32_32x32x16_bf16 v[160:175], v[208:211], v[112:115], v[160:175]
  ds_read_b128 v[132:135], v9 offset:40960
  ds_read_b64_tr_b16 v[228:229], v18 offset:18816
  ds_read_b64_tr_b16 v[230:231], v18 offset:19040
  s_waitcnt lgkmcnt(12)
  v_mfma_f32_32x32x16_bf16 v[160:175], v[212:215], v[116:119], v[160:175]
  ds_read_b128 v[136:139], v10 offset:40960
  ds_read_b64_tr_b16 v[232:233], v18 offset:19712
  ds_read_b64_tr_b16 v[234:235], v18 offset:19936
  s_waitcnt lgkmcnt(12)
  v_mfma_f32_32x32x16_bf16 v[160:175], v[216:219], v[120:123], v[160:175]
  ds_read_b128 v[140:143], v11 offset:40960
  ds_read_b64_tr_b16 v[236:237], v18 offset:20608
  ds_read_b64_tr_b16 v[238:239], v18 offset:20832
  s_waitcnt lgkmcnt(12)
  v_mfma_f32_32x32x16_bf16 v[160:175], v[220:223], v[124:127], v[160:175]
  ds_read_b128 v[144:147], v8 offset:49152
  ds_read_b64_tr_b16 v[208:209], v18 offset:21504
  ds_read_b64_tr_b16 v[210:211], v18 offset:21728
  s_waitcnt lgkmcnt(12)
  v_mfma_f32_32x32x16_bf16 v[160:175], v[224:227], v[128:131], v[160:175]
  ds_read_b128 v[148:151], v9 offset:49152
  ds_read_b64_tr_b16 v[212:213], v18 offset:22400
  ds_read_b64_tr_b16 v[214:215], v18 offset:22624
  s_waitcnt lgkmcnt(12)
  v_mfma_f32_32x32x16_bf16 v[160:175], v[228:231], v[132:135], v[160:175]
  ds_read_b128 v[152:155], v10 offset:49152
  ds_read_b64_tr_b16 v[216:217], v18 offset:23296
  ds_read_b64_tr_b16 v[218:219], v18 offset:23520
  s_waitcnt lgkmcnt(12)
  v_mfma_f32_32x32x16_bf16 v[160:175], v[232:235], v[136:139], v[160:175]
  ds_read_b128 v[156:159], v11 offset:49152
  ds_read_b64_tr_b16 v[220:221], v18 offset:24192
  ds_read_b64_tr_b16 v[222:223], v18 offset:24416
  s_waitcnt lgkmcnt(12)
  v_mfma_f32_32x32x16_bf16 v[160:175], v[236:239], v[140:143], v[160:175]
  s_waitcnt lgkmcnt(9)
  v_mfma_f32_32x32x16_bf16 v[160:175], v[208:211], v[144:147], v[160:175]
  s_waitcnt lgkmcnt(6)
  v_mfma_f32_32x32x16_bf16 v[160:175], v[212:215], v[148:151], v[160:175]
  s_waitcnt lgkmcnt(3)
  v_mfma_f32_32x32x16_bf16 v[160:175], v[216:219], v[152:155], v[160:175]
  s_waitcnt lgkmcnt(0)
  v_mfma_f32_32x32x16_bf16 v[160:175], v[220:223], v[156:159], v[160:175]
  s_nop 11
  s_mov_b32 exec_lo, 0
  v_mov_b32 v172, 0
  v_mov_b32 v173, 0
  v_mov_b32 v174, 0
  v_mov_b32 v175, 0
  s_mov_b64 exec, -1
  v_cvt_pk_bf16_f32 v240, v160, v161
  v_cvt_pk_bf16_f32 v241, v162, v163
  v_cvt_pk_bf16_f32 v242, v164, v165
  v_cvt_pk_bf16_f32 v243, v166, v167
  v_cvt_pk_bf16_f32 v244, v168, v169
  v_cvt_pk_bf16_f32 v245, v170, v171
  v_cvt_pk_bf16_f32 v246, v172, v173
  v_cvt_pk_bf16_f32 v247, v174, v175
  s_lshl_b32 s12, s4, 2
  s_lshl_b32 s11, s82, 1
  s_add_u32 s12, s12, s11
  s_and_b32 s11, s3, 1
  s_add_u32 s12, s12, s11
  s_lshl_b32 s12, s12, 12
  buffer_store_dwordx4 v[240:243], v2, s[64:67], s12 offen offset:0 sc1
  buffer_store_dwordx4 v[244:247], v2, s[64:67], s12 offen offset:1024 sc1
  s_waitcnt vmcnt(0)
  s_barrier
  s_cmp_lg_u32 s3, 0
  s_cbranch_scc1 L_kv_join
  s_mov_b32 s80, 0
tok5:
  v_cmp_ne_u32 vcc, 0, v24
  s_nop 1
  s_cbranch_vccnz tok5_ok
  s_sleep 1
  buffer_load_dwordx2 v[24:25], v15, s[60:63], 0 offen sc1
  s_waitcnt vmcnt(0)
  s_add_u32 s80, s80, 1
  s_cmp_lt_u32 s80, 20000000
  s_cbranch_scc1 tok5
tok5_ok:
  s_lshl_b32 s13, s4, 1
  s_add_u32 s13, s13, s82
  s_lshl_b32 s13, s13, 3
  s_add_u32 s13, s13, 262144
  s_mov_b64 exec, 1
  buffer_store_dwordx2 v[24:25], v15, s[64:67], s13 offen sc1
  s_mov_b64 exec, -1
  s_branch L_kv_join
L_kv_V:
  ds_read_b128 v[48:51], v8 offset:0
  ds_read_b64_tr_b16 v[208:209], v18 offset:0
  ds_read_b64_tr_b16 v[210:211], v18 offset:224
  ds_read_b128 v[52:55], v9 offset:0
  ds_read_b64_tr_b16 v[212:213], v18 offset:896
  ds_read_b64_tr_b16 v[214:215], v18 offset:1120
  ds_read_b128 v[56:59], v10 offset:0
  ds_read_b64_tr_b16 v[216:217], v18 offset:1792
  ds_read_b64_tr_b16 v[218:219], v18 offset:2016
  ds_read_b128 v[60:63], v11 offset:0
  ds_read_b64_tr_b16 v[220:221], v18 offset:2688
  ds_read_b64_tr_b16 v[222:223], v18 offset:2912
  ds_read_b128 v[64:67], v8 offset:8192
  ds_read_b64_tr_b16 v[224:225], v18 offset:3584
  ds_read_b64_tr_b16 v[226:227], v18 offset:3808
  s_waitcnt lgkmcnt(12)
  v_mfma_f32_32x32x16_bf16 v[160:175], v[48:51], v[208:211], 0
  ds_read_b128 v[68:71], v9 offset:8192
  ds_read_b64_tr_b16 v[228:229], v18 offset:4480
  ds_read_b64_tr_b16 v[230:231], v18 offset:4704
  s_waitcnt lgkmcnt(12)
  v_mfma_f32_32x32x16_bf16 v[160:175], v[52:55], v[212:215], v[160:175]
  ds_read_b128 v[72:75], v10 offset:8192
  ds_read_b64_tr_b16 v[232:233], v18 offset:5376
  ds_read_b64_tr_b16 v[234:235], v18 offset:5600
  s_waitcnt lgkmcnt(12)
  v_mfma_f32_32x32x16_bf16 v[160:175], v[56:59], v[216:219], v[160:175]
  ds_read_b128 v[76:79], v11 offset:8192
  ds_read_b64_tr_b16 v[236:237], v18 offset:6272
  ds_read_b64_tr_b16 v[238:239], v18 offset:6496
  s_waitcnt lgkmcnt(12)
  v_mfma_f32_32x32x16_bf16 v[160:175], v[60:63], v[220:223], v[160:175]
  ds_read_b128 v[80:83], v8 offset:16384
  ds_read_b64_tr_b16 v[208:209], v18 offset:7168
  ds_read_b64_tr_b16 v[210:211], v18 offset:7392
  s_waitcnt lgkmcnt(12)
  v_mfma_f32_32x32x16_bf16 v[160:175], v[64:67], v[224:227], v[160:175]
  ds_read_b128 v[84:87], v9 offset:16384
  ds_read_b64_tr_b16 v[212:213], v18 offset:8064
  ds_read_b64_tr_b16 v[214:215], v18 offset:8288
  s_waitcnt lgkmcnt(12)
  v_mfma_f32_32x32x16_bf16 v[160:175], v[68:71], v[228:231], v[160:175]
  ds_read_b128 v[88:91], v10 offset:16384
  ds_read_b64_tr_b16 v[216:217], v18 offset:8960
  ds_read_b64_tr_b16 v[218:219], v18 offset:9184
  s_waitcnt lgkmcnt(12)
  v_mfma_f32_32x32x16_bf16 v[160:175], v[72:75], v[232:235], v[160:175]
  ds_read_b128 v[92:95], v11 offset:16384
  ds_read_b64_tr_b16 v[220:221], v18 offset:9856
  ds_read_b64_tr_b16 v[222:223], v18 offset:10080
  s_waitcnt lgkmcnt(12)
  v_mfma_f32_32x32x16_bf16 v[160:175], v[76:79], v[236:239], v[160:175]
  ds_read_b128 v[96:99], v8 offset:24576
  ds_read_b64_tr_b16 v[224:225], v18 offset:10752
  ds_read_b64_tr_b16 v[226:227], v18 offset:10976
  s_waitcnt lgkmcnt(12)
  v_mfma_f32_32x32x16_bf16 v[160:175], v[80:83], v[208:211], v[160:175]
  ds_read_b128 v[100:103], v9 offset:24576
  ds_read_b64_tr_b16 v[228:229], v18 offset:11648
  ds_read_b64_tr_b16 v[230:231], v18 offset:11872
  s_waitcnt lgkmcnt(12)
  v_mfma_f32_32x32x16_bf16 v[160:175], v[84:87], v[212:215], v[160:175]
  ds_read_b128 v[104:107], v10 offset:24576
  ds_read_b64_tr_b16 v[232:233], v18 offset:12544
  ds_read_b64_tr_b16 v[234:235], v18 offset:12768
  s_waitcnt lgkmcnt(12)
  v_mfma_f32_32x32x16_bf16 v[160:175], v[88:91], v[216:219], v[160:175]
  ds_read_b128 v[108:111], v11 offset:24576
  ds_read_b64_tr_b16 v[236:237], v18 offset:13440
  ds_read_b64_tr_b16 v[238:239], v18 offset:13664
  s_waitcnt lgkmcnt(12)
  v_mfma_f32_32x32x16_bf16 v[160:175], v[92:95], v[220:223], v[160:175]
  s_waitcnt lgkmcnt(9)
  v_mfma_f32_32x32x16_bf16 v[160:175], v[96:99], v[224:227], v[160:175]
  s_waitcnt lgkmcnt(6)
  v_mfma_f32_32x32x16_bf16 v[160:175], v[100:103], v[228:231], v[160:175]
  s_waitcnt lgkmcnt(3)
  v_mfma_f32_32x32x16_bf16 v[160:175], v[104:107], v[232:235], v[160:175]
  s_waitcnt lgkmcnt(0)
  v_mfma_f32_32x32x16_bf16 v[160:175], v[108:111], v[236:239], v[160:175]
  s_waitcnt vmcnt(0)
  s_barrier
  ds_read_b128 v[112:115], v8 offset:32768
  ds_read_b64_tr_b16 v[208:209], v18 offset:14336
  ds_read_b64_tr_b16 v[210:211], v18 offset:14560
  ds_read_b128 v[116:119], v9 offset:32768
  ds_read_b64_tr_b16 v[212:213], v18 offset:15232
  ds_read_b64_tr_b16 v[214:215], v18 offset:15456
  ds_read_b128 v[120:123], v10 offset:32768
  ds_read_b64_tr_b16 v[216:217], v18 offset:16128
  ds_read_b64_tr_b16 v[218:219], v18 offset:16352
  ds_read_b128 v[124:127], v11 offset:32768
  ds_read_b64_tr_b16 v[220:221], v18 offset:17024
  ds_read_b64_tr_b16 v[222:223], v18 offset:17248
  ds_read_b128 v[128:131], v8 offset:40960
  ds_read_b64_tr_b16 v[224:225], v18 offset:17920
  ds_read_b64_tr_b16 v[226:227], v18 offset:18144
  s_waitcnt lgkmcnt(12)
  v_mfma_f32_32x32x16_bf16 v[160:175], v[112:115], v[208:211], v[160:175]
  ds_read_b128 v[132:135], v9 offset:40960
  ds_read_b64_tr_b16 v[228:229], v18 offset:18816
  ds_read_b64_tr_b16 v[230:231], v18 offset:19040
  s_waitcnt lgkmcnt(12)
  v_mfma_f32_32x32x16_bf16 v[160:175], v[116:119], v[212:215], v[160:175]
  ds_read_b128 v[136:139], v10 offset:40960
  ds_read_b64_tr_b16 v[232:233], v18 offset:19712
  ds_read_b64_tr_b16 v[234:235], v18 offset:19936
  s_waitcnt lgkmcnt(12)
  v_mfma_f32_32x32x16_bf16 v[160:175], v[120:123], v[216:219], v[160:175]
  ds_read_b128 v[140:143], v11 offset:40960
  ds_read_b64_tr_b16 v[236:237], v18 offset:20608
  ds_read_b64_tr_b16 v[238:239], v18 offset:20832
  s_waitcnt lgkmcnt(12)
  v_mfma_f32_32x32x16_bf16 v[160:175], v[124:127], v[220:223], v[160:175]
  ds_read_b128 v[144:147], v8 offset:49152
  ds_read_b64_tr_b16 v[208:209], v18 offset:21504
  ds_read_b64_tr_b16 v[210:211], v18 offset:21728
  s_waitcnt lgkmcnt(12)
  v_mfma_f32_32x32x16_bf16 v[160:175], v[128:131], v[224:227], v[160:175]
  ds_read_b128 v[148:151], v9 offset:49152
  ds_read_b64_tr_b16 v[212:213], v18 offset:22400
  ds_read_b64_tr_b16 v[214:215], v18 offset:22624
  s_waitcnt lgkmcnt(12)
  v_mfma_f32_32x32x16_bf16 v[160:175], v[132:135], v[228:231], v[160:175]
  ds_read_b128 v[152:155], v10 offset:49152
  ds_read_b64_tr_b16 v[216:217], v18 offset:23296
  ds_read_b64_tr_b16 v[218:219], v18 offset:23520
  s_waitcnt lgkmcnt(12)
  v_mfma_f32_32x32x16_bf16 v[160:175], v[136:139], v[232:235], v[160:175]
  ds_read_b128 v[156:159], v11 offset:49152
  ds_read_b64_tr_b16 v[220:221], v18 offset:24192
  ds_read_b64_tr_b16 v[222:223], v18 offset:24416
  s_waitcnt lgkmcnt(12)
  v_mfma_f32_32x32x16_bf16 v[160:175], v[140:143], v[236:239], v[160:175]
  s_waitcnt lgkmcnt(9)
  v_mfma_f32_32x32x16_bf16 v[160:175], v[144:147], v[208:211], v[160:175]
  s_waitcnt lgkmcnt(6)
  v_mfma_f32_32x32x16_bf16 v[160:175], v[148:151], v[212:215], v[160:175]
  s_waitcnt lgkmcnt(3)
  v_mfma_f32_32x32x16_bf16 v[160:175], v[152:155], v[216:219], v[160:175]
  s_waitcnt lgkmcnt(0)
  v_mfma_f32_32x32x16_bf16 v[160:175], v[156:159], v[220:223], v[160:175]
  s_nop 11
  s_mov_b32 exec_lo, 0xe0000000
  s_mov_b32 exec_hi, 0xe0000000
  v_mov_b32 v160, 0
  v_mov_b32 v161, 0
  v_mov_b32 v162, 0
  v_mov_b32 v163, 0
  v_mov_b32 v164, 0
  v_mov_b32 v165, 0
  v_mov_b32 v166, 0
  v_mov_b32 v167, 0
  v_mov_b32 v168, 0
  v_mov_b32 v169, 0
  v_mov_b32 v170, 0
  v_mov_b32 v171, 0
  v_mov_b32 v172, 0
  v_mov_b32 v173, 0
  v_mov_b32 v174, 0
  v_mov_b32 v175, 0
  s_mov_b32 exec_lo, 0x10000000
  s_mov_b32 exec_hi, 0x10000000
  v_mov_b32 v160, 1.0
  v_mov_b32 v161, 1.0
  v_mov_b32 v162, 1.0
  v_mov_b32 v163, 1.0
  v_mov_b32 v164, 1.0
  v_mov_b32 v165, 1.0
  v_mov_b32 v166, 1.0
  v_mov_b32 v167, 1.0
  v_mov_b32 v168, 1.0
  v_mov_b32 v169, 1.0
  v_mov_b32 v170, 1.0
  v_mov_b32 v171, 1.0
  v_mov_b32 v172, 1.0
  v_mov_b32 v173, 1.0
  v_mov_b32 v174, 1.0
  v_mov_b32 v175, 1.0
  s_mov_b64 exec, -1
  v_cvt_pk_bf16_f32 v240, v160, v161
  v_cvt_pk_bf16_f32 v241, v162, v163
  v_cvt_pk_bf16_f32 v242, v164, v165
  v_cvt_pk_bf16_f32 v243, v166, v167
  v_cvt_pk_bf16_f32 v244, v168, v169
  v_cvt_pk_bf16_f32 v245, v170, v171
  v_cvt_pk_bf16_f32 v246, v172, v173
  v_cvt_pk_bf16_f32 v247, v174, v175
  s_lshl_b32 s12, s4, 2
  s_lshl_b32 s11, s82, 1
  s_add_u32 s12, s12, s11
  s_and_b32 s11, s3, 1
  s_add_u32 s12, s12, s11
  s_lshl_b32 s12, s12, 12
  buffer_store_dwordx4 v[240:243], v2, s[64:67], s12 offen offset:2048 sc1
  buffer_store_dwordx4 v[244:247], v2, s[64:67], s12 offen offset:3072 sc1
  s_waitcnt vmcnt(0)
  s_barrier
  s_branch L_kv_join
L_kv_idle:
  s_waitcnt vmcnt(0)
  s_barrier
  s_barrier
L_kv_join:
  s_mov_b32 s80, 0
tok6:
  v_cmp_ne_u32 vcc, 0, v24
  s_nop 1
  s_cbranch_vccnz tok6_ok
  s_sleep 1
  buffer_load_dwordx2 v[24:25], v15, s[60:63], 0 offen sc1
  s_waitcnt vmcnt(0)
  s_add_u32 s80, s80, 1
  s_cmp_lt_u32 s80, 20000000
  s_cbranch_scc1 tok6
tok6_ok:
  s_add_u32 m0, s15, 57344
  s_mov_b32 s11, 0
  buffer_load_dwordx4 v4, s[16:19], s11 offen lds
  s_add_u32 m0, s15, 65536
  s_mov_b32 s11, 128
  buffer_load_dwordx4 v4, s[16:19], s11 offen lds
  s_add_u32 m0, s15, 73728
  s_mov_b32 s11, 256
  buffer_load_dwordx4 v4, s[16:19], s11 offen lds
  s_add_u32 m0, s15, 81920
  s_mov_b32 s11, 384
  buffer_load_dwordx4 v4, s[16:19], s11 offen lds
  s_add_u32 m0, s15, 90112
  s_mov_b32 s11, 512
  buffer_load_dwordx4 v4, s[16:19], s11 offen lds
  s_add_u32 m0, s15, 98304
  s_mov_b32 s11, 640
  buffer_load_dwordx4 v4, s[16:19], s11 offen lds
  s_add_u32 m0, s15, 106496
  s_mov_b32 s11, 768
  buffer_load_dwordx4 v4, s[16:19], s11 offen lds
  s_add_u32 s10, s8, 0
  s_add_u32 s11, s10, s69
  s_sub_u32 s72, s11, 7
  s_cmp_ge_u32 s11, 7
  s_cselect_b32 s11, s72, s11
  s_cmp_eq_u32 s10, 7
  s_cselect_b32 s11, 64, s11
  s_lshl_b32 s10, s3, 10
  s_add_u32 m0, s10, 131072
  s_mul_i32 s12, s11, 57344
  s_lshl_b32 s11, s11, 7
  buffer_load_dwordx4 v7, s[20:23], s12 offen lds
  buffer_load_ushort v32, v19, s[52:55], s11 offen
  s_add_u32 s10, s8, 2
  s_add_u32 s11, s10, s69
  s_sub_u32 s72, s11, 7
  s_cmp_ge_u32 s11, 7
  s_cselect_b32 s11, s72, s11
  s_cmp_eq_u32 s10, 7
  s_cselect_b32 s11, 64, s11
  s_lshl_b32 s10, s3, 10
  s_add_u32 m0, s10, 139264
  s_mul_i32 s12, s11, 57344
  s_lshl_b32 s11, s11, 7
  buffer_load_dwordx4 v7, s[20:23], s12 offen lds
  buffer_load_ushort v34, v19, s[52:55], s11 offen
  s_add_u32 s10, s8, 4
  s_add_u32 s11, s10, s69
  s_sub_u32 s72, s11, 7
  s_cmp_ge_u32 s11, 7
  s_cselect_b32 s11, s72, s11
  s_cmp_eq_u32 s10, 7
  s_cselect_b32 s11, 64, s11
  s_lshl_b32 s10, s3, 10
  s_add_u32 m0, s10, 147456
  s_mul_i32 s12, s11, 57344
  s_lshl_b32 s11, s11, 7
  buffer_load_dwordx4 v7, s[20:23], s12 offen lds
  buffer_load_ushort v36, v19, s[52:55], s11 offen
  s_add_u32 s10, s8, 6
  s_add_u32 s11, s10, s69
  s_sub_u32 s72, s11, 7
  s_cmp_ge_u32 s11, 7
  s_cselect_b32 s11, s72, s11
  s_cmp_eq_u32 s10, 7
  s_cselect_b32 s11, 64, s11
  s_lshl_b32 s10, s3, 10
  s_add_u32 m0, s10, 155648
  s_mul_i32 s12, s11, 57344
  s_lshl_b32 s11, s11, 7
  buffer_load_dwordx4 v7, s[20:23], s12 offen lds
  buffer_load_ushort v38, v19, s[52:55], s11 offen
  s_lshl_b32 s10, s7, 4
  s_add_u32 s10, s10, s5
  s_lshl_b32 s10, s10, 1
  s_add_u32 s10, s10, s8
  s_lshl_b32 s10, s10, 10
  s_add_u32 s10, s10, s68
  s_add_u32 s10, s10, 524288
  v_mov_b32 v40, -1
  v_mov_b32 v41, -1
  v_mov_b32 v42, -1
  v_mov_b32 v43, -1
  buffer_store_dwordx4 v[40:43], v2, s[64:67], s10 offen sc1
  s_add_u32 s78, s82, 14
  s_lshl_b32 s78, s78, 3
  s_add_u32 s78, s78, s68
  s_add_u32 s78, s78, 655360
  s_mov_b32 s13, 262144
  s_cmp_eq_u32 s3, 7
  s_cselect_b32 s13, s13, 0x7f000000
  v_and_b32 v130, 31, v1
  v_lshrrev_b32 v118, 5, v1
  s_and_b32 s11, s3, 1
  s_lshl_b32 s11, s11, 5
  v_add_u32 v130, s11, v130
  v_bfe_u32 v119, v130, 1, 3
  v_xor_b32 v119, v119, v118
  v_lshlrev_b32 v129, 7, v130
  v_xor_b32 v121, 0, v119
  v_lshl_add_u32 v8, v121, 4, v129
  v_xor_b32 v121, 2, v119
  v_lshl_add_u32 v9, v121, 4, v129
  v_xor_b32 v121, 4, v119
  v_lshl_add_u32 v10, v121, 4, v129
  v_xor_b32 v121, 6, v119
  v_lshl_add_u32 v11, v121, 4, v129
  s_bfe_u32 s11, s3, 0x10001
  s_cmp_eq_u32 s11, s82
  s_cselect_b32 s11, 0, 57344
  v_add_u32 v8, s11, v8
  v_add_u32 v9, s11, v9
  v_add_u32 v10, s11, v10
  v_add_u32 v11, s11, v11
  s_lshl_b32 s85, s7, 13
  s_waitcnt vmcnt(0)
  ds_write_b64 v14, v[32:33] offset:0
  ds_write_b64 v14, v[34:35] offset:8192
  ds_write_b64 v14, v[36:37] offset:16384
  ds_write_b64 v14, v[38:39] offset:24576
  s_waitcnt lgkmcnt(0)
  s_barrier
  buffer_load_dwordx2 v[26:27], v23, s[64:67], s13 offen sc1
  ds_read_b128 v[48:51], v8 offset:0
  ds_read_b128 v[52:55], v9 offset:0
  ds_read_b128 v[56:59], v10 offset:0
  ds_read_b128 v[60:63], v11 offset:0
  ds_read_b128 v[64:67], v8 offset:8192
  ds_read_b128 v[68:71], v9 offset:8192
  ds_read_b128 v[72:75], v10 offset:8192
  ds_read_b128 v[76:79], v11 offset:8192
  ds_read_b128 v[80:83], v8 offset:16384
  ds_read_b128 v[84:87], v9 offset:16384
  ds_read_b128 v[88:91], v10 offset:16384
  ds_read_b128 v[92:95], v11 offset:16384
  ds_read_b128 v[96:99], v8 offset:24576
  ds_read_b128 v[100:103], v9 offset:24576
  ds_read_b128 v[104:107], v10 offset:24576
  ds_read_b128 v[108:111], v11 offset:24576
  ds_read_b128 v[112:115], v8 offset:32768
  ds_read_b128 v[116:119], v9 offset:32768
  ds_read_b128 v[120:123], v10 offset:32768
  ds_read_b128 v[124:127], v11 offset:32768
  ds_read_b128 v[128:131], v8 offset:40960
  ds_read_b128 v[132:135], v9 offset:40960
  ds_read_b128 v[136:139], v10 offset:40960
  ds_read_b128 v[140:143], v11 offset:40960
  ds_read_b128 v[144:147], v8 offset:49152
  ds_read_b128 v[148:151], v9 offset:49152
  ds_read_b128 v[152:155], v10 offset:49152
  ds_read_b128 v[156:159], v11 offset:49152
  s_waitcnt vmcnt(0) lgkmcnt(0)
  s_cmp_lg_u32 s3, 7
  s_cbranch_scc1 poll7_ok
  s_mov_b32 s72, 0xffffffff
  s_mov_b32 s73, 0x0
  s_mov_b32 s80, 0
poll7:
  v_cmp_eq_u64 vcc, v[26:27], v[24:25]
  s_nop 1
  s_and_b64 vcc, vcc, s[72:73]
  s_cmp_eq_u64 vcc, s[72:73]
  s_cbranch_scc1 poll7_ok
  s_sleep 1
  buffer_load_dwordx2 v[26:27], v23, s[64:67], s13 offen sc1
  s_waitcnt vmcnt(0)
  s_add_u32 s80, s80, 1
  s_cmp_lt_u32 s80, 20000000
  s_cbranch_scc1 poll7
poll7_ok:
  s_barrier
  s_cmp_eq_u32 s8, 0
  s_cbranch_scc0 L_kv_B
  ds_read_b64_tr_b16 v[224:225], v13 offset:0
  ds_read_b64_tr_b16 v[226:227], v13 offset:256
  ds_read_b64_tr_b16 v[228:229], v13 offset:1024
  ds_read_b64_tr_b16 v[230:231], v13 offset:1280
  ds_read_b64_tr_b16 v[232:233], v13 offset:2048
  ds_read_b64_tr_b16 v[234:235], v13 offset:2304
  ds_read_b64_tr_b16 v[236:237], v13 offset:3072
  ds_read_b64_tr_b16 v[238:239], v13 offset:3328
  s_waitcnt lgkmcnt(6)
  v_mfma_f32_32x32x16_bf16 v[192:207], v[224:227], v[48:51], 0
  ds_read_b64_tr_b16 v[224:225], v13 offset:4096
  ds_read_b64_tr_b16 v[226:227], v13 offset:4352
  s_waitcnt lgkmcnt(6)
  v_mfma_f32_32x32x16_bf16 v[192:207], v[228:231], v[52:55], v[192:207]
  ds_read_b64_tr_b16 v[228:229], v13 offset:5120
  ds_read_b64_tr_b16 v[230:231], v13 offset:5376
  s_waitcnt lgkmcnt(6)
  v_mfma_f32_32x32x16_bf16 v[192:207], v[232:235], v[56:59], v[192:207]
  ds_read_b64_tr_b16 v[232:233], v13 offset:6144
  ds_read_b64_tr_b16 v[234:235], v13 offset:6400
  s_waitcnt lgkmcnt(6)
  v_mfma_f32_32x32x16_bf16 v[192:207], v[236:239], v[60:63], v[192:207]
  ds_read_b64_tr_b16 v[236:237], v13 offset:7168
  ds_read_b64_tr_b16 v[238:239], v13 offset:7424
  s_waitcnt lgkmcnt(6)
  v_mfma_f32_32x32x16_bf16 v[192:207], v[224:227], v[64:67], v[192:207]
  ds_read_b64_tr_b16 v[224:225], v13 offset:8192
  ds_read_b64_tr_b16 v[226:227], v13 offset:8448
  s_waitcnt lgkmcnt(6)
  v_mfma_f32_32x32x16_bf16 v[192:207], v[228:231], v[68:71], v[192:207]
  ds_read_b64_tr_b16 v[228:229], v13 offset:9216
  ds_read_b64_tr_b16 v[230:231], v13 offset:9472
  s_waitcnt lgkmcnt(6)
  v_mfma_f32_32x32x16_bf16 v[192:207], v[232:235], v[72:75], v[192:207]
  ds_read_b64_tr_b16 v[232:233], v13 offset:10240
  ds_read_b64_tr_b16 v[234:235], v13 offset:10496
  s_waitcnt lgkmcnt(6)
  v_mfma_f32_32x32x16_bf16 v[192:207], v[236:239], v[76:79], v[192:207]
  ds_read_b64_tr_b16 v[236:237], v13 offset:11264
  ds_read_b64_tr_b16 v[238:239], v13 offset:11520
  s_waitcnt lgkmcnt(6)
  v_mfma_f32_32x32x16_bf16 v[192:207], v[224:227], v[80:83], v[192:207]
  ds_read_b64_tr_b16 v[224:225], v13 offset:12288
  ds_read_b64_tr_b16 v[226:227], v13 offset:12544
  s_waitcnt lgkmcnt(6)
  v_mfma_f32_32x32x16_bf16 v[192:207], v[228:231], v[84:87], v[192:207]
  ds_read_b64_tr_b16 v[228:229], v13 offset:13312
  ds_read_b64_tr_b16 v[230:231], v13 offset:13568
  s_waitcnt lgkmcnt(6)
  v_mfma_f32_32x32x16_bf16 v[192:207], v[232:235], v[88:91], v[192:207]
  ds_read_b64_tr_b16 v[232:233], v13 offset:14336
  ds_read_b64_tr_b16 v[234:235], v13 offset:14592
  s_waitcnt lgkmcnt(6)
  v_mfma_f32_32x32x16_bf16 v[192:207], v[236:239], v[92:95], v[192:207]
  ds_read_b64_tr_b16 v[236:237], v13 offset:15360
  ds_read_b64_tr_b16 v[238:239], v13 offset:15616
  s_waitcnt lgkmcnt(6)
  v_mfma_f32_32x32x16_bf16 v[192:207], v[224:227], v[96:99], v[192:207]
  ds_read_b64_tr_b16 v[224:225], v13 offset:16384
  ds_read_b64_tr_b16 v[226:227], v13 offset:16640
  s_waitcnt lgkmcnt(6)
  v_mfma_f32_32x32x16_bf16 v[192:207], v[228:231], v[100:103], v[192:207]
  ds_read_b64_tr_b16 v[228:229], v13 offset:17408
  ds_read_b64_tr_b16 v[230:231], v13 offset:17664
  s_waitcnt lgkmcnt(6)
  v_mfma_f32_32x32x16_bf16 v[192:207], v[232:235], v[104:107], v[192:207]
  ds_read_b64_tr_b16 v[232:233], v13 offset:18432
  ds_read_b64_tr_b16 v[234:235], v13 offset:18688
  s_waitcnt lgkmcnt(6)
  v_mfma_f32_32x32x16_bf16 v[192:207], v[236:239], v[108:111], v[192:207]
  ds_read_b64_tr_b16 v[236:237], v13 offset:19456
  ds_read_b64_tr_b16 v[238:239], v13 offset:19712
  s_waitcnt lgkmcnt(6)
  v_mfma_f32_32x32x16_bf16 v[192:207], v[224:227], v[112:115], v[192:207]
  ds_read_b64_tr_b16 v[224:225], v13 offset:20480
  ds_read_b64_tr_b16 v[226:227], v13 offset:20736
  s_waitcnt lgkmcnt(6)
  v_mfma_f32_32x32x16_bf16 v[192:207], v[228:231], v[116:119], v[192:207]
  ds_read_b64_tr_b16 v[228:229], v13 offset:21504
  ds_read_b64_tr_b16 v[230:231], v13 offset:21760
  s_waitcnt lgkmcnt(6)
  v_mfma_f32_32x32x16_bf16 v[192:207], v[232:235], v[120:123], v[192:207]
  ds_read_b64_tr_b16 v[232:233], v13 offset:22528
  ds_read_b64_tr_b16 v[234:235], v13 offset:22784
  s_waitcnt lgkmcnt(6)
  v_mfma_f32_32x32x16_bf16 v[192:207], v[236:239], v[124:127], v[192:207]
  ds_read_b64_tr_b16 v[236:237], v13 offset:23552
  ds_read_b64_tr_b16 v[238:239], v13 offset:23808
  s_waitcnt lgkmcnt(6)
  v_mfma_f32_32x32x16_bf16 v[192:207], v[224:227], v[128:131], v[192:207]
  ds_read_b64_tr_b16 v[224:225], v13 offset:24576
  ds_read_b64_tr_b16 v[226:227], v13 offset:24832
  s_waitcnt lgkmcnt(6)
  v_mfma_f32_32x32x16_bf16 v[192:207], v[228:231], v[132:135], v[192:207]
  ds_read_b64_tr_b16 v[228:229], v13 offset:25600
  ds_read_b64_tr_b16 v[230:231], v13 offset:25856
  s_waitcnt lgkmcnt(6)
  v_mfma_f32_32x32x16_bf16 v[192:207], v[232:235], v[136:139], v[192:207]
  ds_read_b64_tr_b16 v[232:233], v13 offset:26624
  ds_read_b64_tr_b16 v[234:235], v13 offset:26880
  s_waitcnt lgkmcnt(6)
  v_mfma_f32_32x32x16_bf16 v[192:207], v[236:239], v[140:143], v[192:207]
  ds_read_b64_tr_b16 v[236:237], v13 offset:27648
  ds_read_b64_tr_b16 v[238:239], v13 offset:27904
  s_waitcnt lgkmcnt(6)
  v_mfma_f32_32x32x16_bf16 v[192:207], v[224:227], v[144:147], v[192:207]
  s_waitcnt lgkmcnt(4)
  v_mfma_f32_32x32x16_bf16 v[192:207], v[228:231], v[148:151], v[192:207]
  s_waitcnt lgkmcnt(2)
  v_mfma_f32_32x32x16_bf16 v[192:207], v[232:235], v[152:155], v[192:207]
  s_waitcnt lgkmcnt(0)
  v_mfma_f32_32x32x16_bf16 v[192:207], v[236:239], v[156:159], v[192:207]
  s_lshl_b32 s10, s7, 8
  s_add_u32 s10, s10, 110592
  v_lshl_add_u32 v18, v1, 2, s10
  s_nop 8
  v_mul_f32 v28, 0xbfb8aa3b, v204
  v_exp_f32 v28, v28
  s_mov_b32 exec_lo, 0
  v_mov_b32 v204, 0
  v_mov_b32 v205, 0
  v_mov_b32 v206, 0
  v_mov_b32 v207, 0
  s_mov_b64 exec, -1
  v_add_f32 v28, 1.0, v28
  v_rcp_f32 v28, v28
  s_mov_b32 s74, 0x3e8b97f6
  s_mov_b32 s75, 0x3e8b97f6
  v_pk_mul_f32 v[192:193], v[192:193], s[74:75]
  v_pk_mul_f32 v[194:195], v[194:195], s[74:75]
  v_pk_mul_f32 v[196:197], v[196:197], s[74:75]
  v_pk_mul_f32 v[198:199], v[198:199], s[74:75]
  v_mov_b32 v29, v28
  v_pk_mul_f32 v[200:201], v[200:201], s[74:75]
  v_pk_mul_f32 v[202:203], v[202:203], s[74:75]
  v_pk_mul_f32 v[204:205], v[204:205], s[74:75]
  v_pk_mul_f32 v[206:207], v[206:207], s[74:75]
  v_permlane32_swap_b32 v29, v28
  v_cvt_pk_bf16_f32 v40, v192, v193
  v_cvt_pk_bf16_f32 v41, v194, v195
  v_cvt_pk_bf16_f32 v42, v196, v197
  v_cvt_pk_bf16_f32 v43, v198, v199
  v_cvt_pk_bf16_f32 v44, v200, v201
  v_cvt_pk_bf16_f32 v45, v202, v203
  v_cvt_pk_bf16_f32 v46, v204, v205
  v_cvt_pk_bf16_f32 v47, v206, v207
  ds_write_b32 v18, v28
  s_waitcnt lgkmcnt(0)
  s_barrier
  s_branch L_attn
L_kv_B:
  s_add_u32 s81, s5, 0
  s_and_b32 s81, s81, 7
  s_lshl_b32 s81, s81, 15
  s_add_u32 s81, s81, s85
  s_add_u32 m0, s85, 0
  s_nop 0
  buffer_load_dwordx4 v2, s[64:67], s81 offen offset:0 sc1 lds
  buffer_load_dwordx4 v2, s[64:67], s81 offen offset:1024 sc1 lds
  buffer_load_dwordx4 v2, s[64:67], s81 offen offset:2048 sc1 lds
  buffer_load_dwordx4 v2, s[64:67], s81 offen offset:3072 sc1 lds
  s_add_u32 m0, s85, 4096
  s_add_u32 s81, s81, 4096
  buffer_load_dwordx4 v2, s[64:67], s81 offen offset:0 sc1 lds
  buffer_load_dwordx4 v2, s[64:67], s81 offen offset:1024 sc1 lds
  buffer_load_dwordx4 v2, s[64:67], s81 offen offset:2048 sc1 lds
  buffer_load_dwordx4 v2, s[64:67], s81 offen offset:3072 sc1 lds
  s_lshl_b32 s10, s82, 1
  s_and_b32 s11, s3, 1
  s_add_u32 s76, s10, s11
  s_lshl_b32 s10, s76, 8
  s_add_u32 s10, s10, 110592
  v_lshl_add_u32 v16, v1, 2, s10
  s_waitcnt vmcnt(0)
  s_waitcnt lgkmcnt(0)
  s_barrier
  s_branch L_serv
L_attn:
  s_setprio 2
  v_mov_b32 v3, v2
  v_add_u32 v4, 32768, v2
  ds_read_b128 v[120:123], v3 offset:0
  ds_read_b128 v[124:127], v3 offset:1024
  ds_read_b128 v[128:131], v3 offset:4096
  ds_read_b128 v[132:135], v3 offset:5120
  ds_read_b128 v[136:139], v3 offset:2048
  ds_read_b128 v[140:143], v3 offset:3072
  ds_read_b128 v[144:147], v3 offset:6144
  ds_read_b128 v[148:151], v3 offset:7168
  s_mov_b32 s76, 32768
  s_mov_b32 s77, 65536
  s_mov_b32 s78, 0
  s_mov_b32 s79, 0
  v_mov_b32 v116, 0
  v_mov_b32 v117, 0
  v_mov_b32 v118, 0
  v_mov_b32 v119, 0
  v_mov_b32 v164, 0
  v_mov_b32 v165, 0
  v_mov_b32 v166, 0
  v_mov_b32 v167, 0
  v_mov_b32 v92, 0
  v_mov_b32 v93, 0
  v_mov_b32 v94, 0
  v_mov_b32 v95, 0
  s_waitcnt lgkmcnt(6)
  v_mfma_f32_32x32x16_bf16 v[64:79], v[120:123], v[40:43], 0
  v_mfma_f32_32x32x16_bf16 v[64:79], v[124:127], v[44:47], v[64:79]
  v_mov_b32 v96, 0
  v_mov_b32 v97, 0
  v_mov_b32 v98, 0
  v_mov_b32 v99, 0
  v_mov_b32 v100, 0
  v_mov_b32 v101, 0
  v_mov_b32 v102, 0
  v_mov_b32 v103, 0
  v_mov_b32 v104, 0
  v_mov_b32 v105, 0
  v_mov_b32 v106, 0
  v_mov_b32 v107, 0
  v_mov_b32 v108, 0
  v_mov_b32 v109, 0
  v_mov_b32 v110, 0
  v_mov_b32 v111, 0
  v_max3_f32 v248, v64, v65, v66
  v_max3_f32 v249, v67, v68, v69
  v_max3_f32 v250, v70, v71, v72
  v_max3_f32 v251, v73, v74, v75
  v_max3_f32 v248, v248, v76, v77
  v_max3_f32 v249, v249, v78, v79
  v_max3_f32 v248, v248, v249, v250
  v_max_f32 v248, v248, v251
  v_mov_b32 v249, v248
  s_nop 1
  v_permlane32_swap_b32 v248, v249
  s_nop 0
  v_max_f32 v248, v248, v249
  v_mov_b32 v249, v248
  v_pk_mul_f32 v[48:49], v[248:249], -1.0 op_sel_hi:[1,0]
  v_pk_mul_f32 v[50:51], v[248:249], -1.0 op_sel_hi:[1,0]
  v_pk_mul_f32 v[52:53], v[248:249], -1.0 op_sel_hi:[1,0]
  v_pk_mul_f32 v[54:55], v[248:249], -1.0 op_sel_hi:[1,0]
  v_pk_mul_f32 v[56:57], v[248:249], -1.0 op_sel_hi:[1,0]
  v_pk_mul_f32 v[58:59], v[248:249], -1.0 op_sel_hi:[1,0]
  v_pk_mul_f32 v[60:61], v[248:249], -1.0 op_sel_hi:[1,0]
  v_pk_mul_f32 v[62:63], v[248:249], -1.0 op_sel_hi:[1,0]
  v_pk_add_f32 v[64:65], v[64:65], v[48:49]
  v_pk_add_f32 v[66:67], v[66:67], v[48:49]
  v_pk_add_f32 v[68:69], v[68:69], v[48:49]
  v_pk_add_f32 v[70:71], v[70:71], v[48:49]
  v_pk_add_f32 v[72:73], v[72:73], v[48:49]
  v_pk_add_f32 v[74:75], v[74:75], v[48:49]
  v_pk_add_f32 v[76:77], v[76:77], v[48:49]
  v_pk_add_f32 v[78:79], v[78:79], v[48:49]
  s_waitcnt lgkmcnt(0)
.p2align 6
L_aloop:
  v_mfma_f32_32x32x16_bf16 v[80:95], v[128:131], v[40:43], v[48:63]
  v_exp_f32 v64, v64
  v_exp_f32 v65, v65
  v_exp_f32_e64 v66, v66
  v_mfma_f32_32x32x16_bf16 v[80:95], v[132:135], v[44:47], v[80:95]
  ds_read_b128 v[120:123], v3 offset:8192
  ds_read_b128 v[124:127], v3 offset:9216
  v_exp_f32 v67, v67
  v_exp_f32 v68, v68
  v_exp_f32 v69, v69
  v_exp_f32 v70, v70
  v_exp_f32_e64 v71, v71
  v_cvt_pk_bf16_f32 v112, v64, v65
  v_cvt_pk_bf16_f32 v113, v66, v67
  v_cvt_pk_bf16_f32 v114, v68, v69
  v_cvt_pk_bf16_f32 v115, v70, v71
  v_mfma_f32_32x32x16_bf16 v[96:111], v[164:167], v[116:119], v[96:111]
  v_exp_f32 v72, v72
  v_exp_f32 v73, v73
  v_exp_f32_e64 v74, v74
  v_mfma_f32_32x32x16_bf16 v[96:111], v[136:139], v[112:115], v[96:111]
  ds_read_b128 v[152:155], v3 offset:10240
  ds_read_b128 v[156:159], v3 offset:11264
  v_exp_f32 v75, v75
  v_exp_f32 v76, v76
  v_exp_f32 v77, v77
  v_exp_f32 v78, v78
  v_exp_f32 v79, v79
  s_waitcnt lgkmcnt(2)
  v_cvt_pk_bf16_f32 v116, v72, v73
  v_cvt_pk_bf16_f32 v117, v74, v75
  v_cvt_pk_bf16_f32 v118, v76, v77
  v_cvt_pk_bf16_f32 v119, v78, v79
  v_mfma_f32_32x32x16_bf16 v[64:79], v[120:123], v[40:43], v[48:63]
  v_exp_f32 v80, v80
  v_exp_f32 v81, v81
  v_exp_f32_e64 v82, v82
  v_mfma_f32_32x32x16_bf16 v[64:79], v[124:127], v[44:47], v[64:79]
  ds_read_b128 v[128:131], v3 offset:12288
  ds_read_b128 v[132:135], v3 offset:13312
  v_exp_f32 v83, v83
  v_exp_f32 v84, v84
  v_exp_f32 v85, v85
  v_exp_f32 v86, v86
  v_exp_f32_e64 v87, v87
  v_cvt_pk_bf16_f32 v112, v80, v81
  v_cvt_pk_bf16_f32 v113, v82, v83
  v_cvt_pk_bf16_f32 v114, v84, v85
  v_cvt_pk_bf16_f32 v115, v86, v87
  v_mfma_f32_32x32x16_bf16 v[96:111], v[140:143], v[116:119], v[96:111]
  v_exp_f32 v88, v88
  v_exp_f32 v89, v89
  v_exp_f32_e64 v90, v90
  v_mfma_f32_32x32x16_bf16 v[96:111], v[144:147], v[112:115], v[96:111]
  ds_read_b128 v[160:163], v3 offset:14336
  ds_read_b128 v[164:167], v3 offset:15360
  v_exp_f32 v91, v91
  v_exp_f32 v92, v92
  v_exp_f32 v93, v93
  v_exp_f32 v94, v94
  v_exp_f32 v95, v95
  s_waitcnt lgkmcnt(2)
  v_cvt_pk_bf16_f32 v116, v88, v89
  v_cvt_pk_bf16_f32 v117, v90, v91
  v_cvt_pk_bf16_f32 v118, v92, v93
  v_cvt_pk_bf16_f32 v119, v94, v95
  v_mfma_f32_32x32x16_bf16 v[80:95], v[128:131], v[40:43], v[48:63]
  v_exp_f32 v64, v64
  v_exp_f32 v65, v65
  v_exp_f32_e64 v66, v66
  v_mfma_f32_32x32x16_bf16 v[80:95], v[132:135], v[44:47], v[80:95]
  ds_read_b128 v[120:123], v3 offset:16384
  ds_read_b128 v[124:127], v3 offset:17408
  v_exp_f32 v67, v67
  v_exp_f32 v68, v68
  v_exp_f32 v69, v69
  v_exp_f32 v70, v70
  v_exp_f32_e64 v71, v71
  v_cvt_pk_bf16_f32 v112, v64, v65
  v_cvt_pk_bf16_f32 v113, v66, v67
  v_cvt_pk_bf16_f32 v114, v68, v69
  v_cvt_pk_bf16_f32 v115, v70, v71
  v_mfma_f32_32x32x16_bf16 v[96:111], v[148:151], v[116:119], v[96:111]
  v_exp_f32 v72, v72
  v_exp_f32 v73, v73
  v_exp_f32_e64 v74, v74
  v_mfma_f32_32x32x16_bf16 v[96:111], v[152:155], v[112:115], v[96:111]
  ds_read_b128 v[136:139], v3 offset:18432
  ds_read_b128 v[140:143], v3 offset:19456
  v_exp_f32 v75, v75
  v_exp_f32 v76, v76
  v_exp_f32 v77, v77
  v_exp_f32 v78, v78
  v_exp_f32 v79, v79
  s_waitcnt lgkmcnt(2)
  v_cvt_pk_bf16_f32 v116, v72, v73
  v_cvt_pk_bf16_f32 v117, v74, v75
  v_cvt_pk_bf16_f32 v118, v76, v77
  v_cvt_pk_bf16_f32 v119, v78, v79
  v_mfma_f32_32x32x16_bf16 v[64:79], v[120:123], v[40:43], v[48:63]
  v_exp_f32 v80, v80
  v_exp_f32 v81, v81
  v_exp_f32_e64 v82, v82
  v_mfma_f32_32x32x16_bf16 v[64:79], v[124:127], v[44:47], v[64:79]
  ds_read_b128 v[128:131], v3 offset:20480
  ds_read_b128 v[132:135], v3 offset:21504
  v_exp_f32 v83, v83
  v_exp_f32 v84, v84
  v_exp_f32 v85, v85
  v_exp_f32 v86, v86
  v_exp_f32_e64 v87, v87
  v_cvt_pk_bf16_f32 v112, v80, v81
  v_cvt_pk_bf16_f32 v113, v82, v83
  v_cvt_pk_bf16_f32 v114, v84, v85
  v_cvt_pk_bf16_f32 v115, v86, v87
  v_mfma_f32_32x32x16_bf16 v[96:111], v[156:159], v[116:119], v[96:111]
  v_exp_f32 v88, v88
  v_exp_f32 v89, v89
  v_exp_f32_e64 v90, v90
  v_mfma_f32_32x32x16_bf16 v[96:111], v[160:163], v[112:115], v[96:111]
  ds_read_b128 v[144:147], v3 offset:22528
  ds_read_b128 v[148:151], v3 offset:23552
  v_exp_f32 v91, v91
  v_exp_f32 v92, v92
  v_exp_f32 v93, v93
  v_exp_f32 v94, v94
  v_exp_f32 v95, v95
  s_waitcnt lgkmcnt(2)
  v_cvt_pk_bf16_f32 v116, v88, v89
  v_cvt_pk_bf16_f32 v117, v90, v91
  v_cvt_pk_bf16_f32 v118, v92, v93
  v_cvt_pk_bf16_f32 v119, v94, v95
  v_mfma_f32_32x32x16_bf16 v[80:95], v[128:131], v[40:43], v[48:63]
  v_exp_f32 v64, v64
  v_exp_f32 v65, v65
  v_exp_f32_e64 v66, v66
  v_mfma_f32_32x32x16_bf16 v[80:95], v[132:135], v[44:47], v[80:95]
  ds_read_b128 v[120:123], v3 offset:24576
  ds_read_b128 v[124:127], v3 offset:25600
  v_exp_f32 v67, v67
  v_exp_f32 v68, v68
  v_exp_f32 v69, v69
  v_exp_f32 v70, v70
  v_exp_f32_e64 v71, v71
  v_cvt_pk_bf16_f32 v112, v64, v65
  v_cvt_pk_bf16_f32 v113, v66, v67
  v_cvt_pk_bf16_f32 v114, v68, v69
  v_cvt_pk_bf16_f32 v115, v70, v71
  v_mfma_f32_32x32x16_bf16 v[96:111], v[164:167], v[116:119], v[96:111]
  v_exp_f32 v72, v72
  v_exp_f32 v73, v73
  v_exp_f32_e64 v74, v74
  v_mfma_f32_32x32x16_bf16 v[96:111], v[136:139], v[112:115], v[96:111]
  ds_read_b128 v[152:155], v3 offset:26624
  ds_read_b128 v[156:159], v3 offset:27648
  v_exp_f32 v75, v75
  v_exp_f32 v76, v76
  v_exp_f32 v77, v77
  v_exp_f32 v78, v78
  v_exp_f32 v79, v79
  s_waitcnt lgkmcnt(2)
  v_cvt_pk_bf16_f32 v116, v72, v73
  v_cvt_pk_bf16_f32 v117, v74, v75
  v_cvt_pk_bf16_f32 v118, v76, v77
  v_cvt_pk_bf16_f32 v119, v78, v79
  v_mfma_f32_32x32x16_bf16 v[64:79], v[120:123], v[40:43], v[48:63]
  v_exp_f32 v80, v80
  v_exp_f32 v81, v81
  v_exp_f32_e64 v82, v82
  v_mfma_f32_32x32x16_bf16 v[64:79], v[124:127], v[44:47], v[64:79]
  ds_read_b128 v[128:131], v3 offset:28672
  ds_read_b128 v[132:135], v3 offset:29696
  v_exp_f32 v83, v83
  v_exp_f32 v84, v84
  v_exp_f32 v85, v85
  v_exp_f32 v86, v86
  v_exp_f32_e64 v87, v87
  v_cvt_pk_bf16_f32 v112, v80, v81
  v_cvt_pk_bf16_f32 v113, v82, v83
  v_cvt_pk_bf16_f32 v114, v84, v85
  v_cvt_pk_bf16_f32 v115, v86, v87
  v_mfma_f32_32x32x16_bf16 v[96:111], v[140:143], v[116:119], v[96:111]
  v_exp_f32 v88, v88
  v_exp_f32 v89, v89
  v_exp_f32_e64 v90, v90
  v_mfma_f32_32x32x16_bf16 v[96:111], v[144:147], v[112:115], v[96:111]
  ds_read_b128 v[160:163], v3 offset:30720
  ds_read_b128 v[164:167], v3 offset:31744
  v_exp_f32 v91, v91
  v_exp_f32 v92, v92
  v_exp_f32 v93, v93
  v_exp_f32 v94, v94
  v_exp_f32 v95, v95
  s_waitcnt lgkmcnt(2)
  v_cvt_pk_bf16_f32 v116, v88, v89
  v_cvt_pk_bf16_f32 v117, v90, v91
  v_cvt_pk_bf16_f32 v118, v92, v93
  v_cvt_pk_bf16_f32 v119, v94, v95
  v_mfma_f32_32x32x16_bf16 v[80:95], v[128:131], v[40:43], v[48:63]
  v_exp_f32 v64, v64
  v_exp_f32 v65, v65
  v_exp_f32_e64 v66, v66
  v_mfma_f32_32x32x16_bf16 v[80:95], v[132:135], v[44:47], v[80:95]
  s_waitcnt vmcnt(0)
  s_barrier
  ds_read_b128 v[120:123], v4 offset:0
  ds_read_b128 v[124:127], v4 offset:1024
  v_exp_f32 v67, v67
  v_exp_f32 v68, v68
  v_exp_f32 v69, v69
  v_exp_f32 v70, v70
  v_exp_f32_e64 v71, v71
  v_cvt_pk_bf16_f32 v112, v64, v65
  v_cvt_pk_bf16_f32 v113, v66, v67
  v_cvt_pk_bf16_f32 v114, v68, v69
  v_cvt_pk_bf16_f32 v115, v70, v71
  v_mfma_f32_32x32x16_bf16 v[96:111], v[148:151], v[116:119], v[96:111]
  v_exp_f32 v72, v72
  v_exp_f32 v73, v73
  v_exp_f32_e64 v74, v74
  v_mfma_f32_32x32x16_bf16 v[96:111], v[152:155], v[112:115], v[96:111]
  ds_read_b128 v[136:139], v4 offset:2048
  ds_read_b128 v[140:143], v4 offset:3072
  v_exp_f32 v75, v75
  v_exp_f32 v76, v76
  v_exp_f32 v77, v77
  v_exp_f32 v78, v78
  v_exp_f32 v79, v79
  s_waitcnt lgkmcnt(2)
  v_cvt_pk_bf16_f32 v116, v72, v73
  v_cvt_pk_bf16_f32 v117, v74, v75
  v_cvt_pk_bf16_f32 v118, v76, v77
  v_cvt_pk_bf16_f32 v119, v78, v79
  v_mfma_f32_32x32x16_bf16 v[64:79], v[120:123], v[40:43], v[48:63]
  v_exp_f32 v80, v80
  v_exp_f32 v81, v81
  v_exp_f32_e64 v82, v82
  v_mfma_f32_32x32x16_bf16 v[64:79], v[124:127], v[44:47], v[64:79]
  ds_read_b128 v[128:131], v4 offset:4096
  ds_read_b128 v[132:135], v4 offset:5120
  v_exp_f32 v83, v83
  v_exp_f32 v84, v84
  v_exp_f32 v85, v85
  v_exp_f32 v86, v86
  v_exp_f32_e64 v87, v87
  v_cvt_pk_bf16_f32 v112, v80, v81
  v_cvt_pk_bf16_f32 v113, v82, v83
  v_cvt_pk_bf16_f32 v114, v84, v85
  v_cvt_pk_bf16_f32 v115, v86, v87
  v_mfma_f32_32x32x16_bf16 v[96:111], v[156:159], v[116:119], v[96:111]
  v_exp_f32 v88, v88
  v_exp_f32 v89, v89
  v_exp_f32_e64 v90, v90
  v_mfma_f32_32x32x16_bf16 v[96:111], v[160:163], v[112:115], v[96:111]
  ds_read_b128 v[144:147], v4 offset:6144
  ds_read_b128 v[148:151], v4 offset:7168
  v_mov_b32 v3, v4
  v_add_u32 v4, s77, v2
  s_mov_b32 s10, s76
  s_mov_b32 s76, s77
  s_mov_b32 s77, s78
  s_mov_b32 s78, s10
  s_add_u32 s79, s79, 1
  s_cmp_lt_u32 s79, 8
  v_exp_f32 v91, v91
  v_exp_f32 v92, v92
  v_exp_f32 v93, v93
  v_exp_f32 v94, v94
  v_exp_f32 v95, v95
  s_waitcnt lgkmcnt(2)
  v_cvt_pk_bf16_f32 v116, v88, v89
  v_cvt_pk_bf16_f32 v117, v90, v91
  v_cvt_pk_bf16_f32 v118, v92, v93
  v_cvt_pk_bf16_f32 v119, v94, v95
  s_cbranch_scc1 L_aloop
  s_mov_b32 s10, 0x5f800000
  s_nop 0
  v_mfma_f32_32x32x16_bf16 v[96:111], v[164:167], v[116:119], v[96:111]
  s_lshl_b32 s11, s7, 4
  s_add_u32 s11, s11, s5
  s_lshl_b32 s84, s11, 11
  s_add_u32 s84, s84, s68
  s_add_u32 s84, s84, 524288
  s_nop 6
  v_add_f32 v64, |v96|, |v97|
  v_add_f32 v65, |v98|, |v99|
  v_add_f32 v64, v64, |v100|
  v_add_f32 v65, v65, |v101|
  v_add_f32 v64, v64, |v102|
  v_add_f32 v65, v65, |v103|
  v_add_f32 v64, v64, |v104|
  v_add_f32 v65, v65, |v105|
  v_add_f32 v64, v64, |v106|
  v_add_f32 v65, v65, |v107|
  v_add_f32 v64, v64, |v108|
  v_add_f32 v65, v65, |v109|
  v_add_f32 v64, v64, |v110|
  v_add_f32 v65, v65, |v111|
  v_add_f32 v64, v64, v65
  v_cmp_ngt_f32 vcc, s10, v64
  s_nop 1
  s_cmp_lg_u64 vcc, 0
  s_cbranch_scc1 L_slow
L_slow_ret:
  v_mov_b32 v66, v108
  v_mov_b32 v67, v108
  s_nop 1
  v_permlane32_swap_b32 v66, v67
  s_nop 0
  v_rcp_f32 v67, v67
  s_mov_b32 exec_lo, 0
  v_mov_b32 v108, 0
  v_mov_b32 v109, 0
  v_mov_b32 v110, 0
  v_mov_b32 v111, 0
  s_mov_b64 exec, -1
  v_mul_f32 v67, v28, v67
  v_mul_f32 v96, v67, v96
  v_mul_f32 v97, v67, v97
  v_mul_f32 v98, v67, v98
  v_mul_f32 v99, v67, v99
  v_mul_f32 v100, v67, v100
  v_mul_f32 v101, v67, v101
  v_mul_f32 v102, v67, v102
  v_mul_f32 v103, v67, v103
  v_mul_f32 v104, v67, v104
  v_mul_f32 v105, v67, v105
  v_mul_f32 v106, v67, v106
  v_mul_f32 v107, v67, v107
  v_mul_f32 v108, v67, v108
  v_mul_f32 v109, v67, v109
  v_mul_f32 v110, v67, v110
  v_mul_f32 v111, v67, v111
  v_cvt_pk_bf16_f32 v112, v96, v97
  v_cvt_pk_bf16_f32 v113, v98, v99
  v_cvt_pk_bf16_f32 v114, v100, v101
  v_cvt_pk_bf16_f32 v115, v102, v103
  v_cvt_pk_bf16_f32 v116, v104, v105
  v_cvt_pk_bf16_f32 v117, v106, v107
  v_cvt_pk_bf16_f32 v118, v108, v109
  v_cvt_pk_bf16_f32 v119, v110, v111
  v_min_u32 v112, -2, v112
  v_min_u32 v113, -2, v113
  v_min_u32 v114, -2, v114
  v_min_u32 v115, -2, v115
  buffer_store_dwordx4 v[112:115], v2, s[64:67], s84 offen sc1
  v_min_u32 v116, -2, v116
  v_min_u32 v117, -2, v117
  v_min_u32 v118, -2, v118
  v_min_u32 v119, -2, v119
  buffer_store_dwordx4 v[116:119], v2, s[64:67], s84 offen offset:1024 sc1
  s_setprio 0
  s_cmp_eq_u32 s9, 7
  s_cbranch_scc1 L_done
  v_mov_b32 v184, 0
  v_mov_b32 v185, 0
  v_mov_b32 v186, 0
  v_mov_b32 v187, 0
  v_mov_b32 v188, 0
  v_mov_b32 v189, 0
  v_mov_b32 v190, 0
  v_mov_b32 v191, 0
  v_mov_b32 v192, 0
  v_mov_b32 v193, 0
  v_mov_b32 v194, 0
  v_mov_b32 v195, 0
  v_mov_b32 v196, 0
  v_mov_b32 v197, 0
  v_mov_b32 v198, 0
  v_mov_b32 v199, 0
  v_mov_b32 v200, 0
  v_mov_b32 v201, 0
  v_mov_b32 v202, 0
  v_mov_b32 v203, 0
  v_mov_b32 v204, 0
  v_mov_b32 v205, 0
  v_mov_b32 v206, 0
  v_mov_b32 v207, 0
  v_mov_b32 v208, 0
  v_mov_b32 v209, 0
  v_mov_b32 v210, 0
  v_mov_b32 v211, 0
  v_mov_b32 v212, 0
  v_mov_b32 v213, 0
  v_mov_b32 v214, 0
  v_mov_b32 v215, 0
  s_branch L_afin
L_serv:
  ds_read_b32 v28, v16
  v_xor_b32 v16, 256, v16
  ds_read_b32 v31, v16
  s_add_u32 s81, s5, 1
  s_and_b32 s81, s81, 7
  s_lshl_b32 s81, s81, 15
  s_add_u32 s81, s81, s85
  s_add_u32 m0, s85, 32768
  s_nop 0
  buffer_load_dwordx4 v2, s[64:67], s81 offen offset:0 sc1 lds
  buffer_load_dwordx4 v2, s[64:67], s81 offen offset:1024 sc1 lds
  buffer_load_dwordx4 v2, s[64:67], s81 offen offset:2048 sc1 lds
  buffer_load_dwordx4 v2, s[64:67], s81 offen offset:3072 sc1 lds
  s_add_u32 m0, s85, 36864
  s_add_u32 s81, s81, 4096
  buffer_load_dwordx4 v2, s[64:67], s81 offen offset:0 sc1 lds
  buffer_load_dwordx4 v2, s[64:67], s81 offen offset:1024 sc1 lds
  buffer_load_dwordx4 v2, s[64:67], s81 offen offset:2048 sc1 lds
  buffer_load_dwordx4 v2, s[64:67], s81 offen offset:3072 sc1 lds
L_serv2:
  s_add_u32 s79, s68, 655360
  s_mul_i32 s11, s7, 28
  s_mul_i32 s14, s76, 112
  s_add_u32 s14, s14, s11
  s_lshl_b32 s14, s14, 10
  s_add_u32 s14, s14, s68
  s_xor_b32 s15, s76, 1
  s_mul_i32 s15, s15, 112
  s_add_u32 s15, s15, s11
  s_lshl_b32 s15, s15, 10
  s_add_u32 s15, s15, s68
  s_mul_i32 s13, s7, 401408
  s_lshl_b32 s84, s7, 14
  s_add_u32 s84, s84, 98304
  s_lshr_b32 s11, s3, 1
  s_lshl_b32 s11, s11, 12
  s_sub_u32 s11, s84, s11
  v_add_u32 v7, s11, v21
  v_add_u32 v8, s11, v20
  v_add_u32 v9, 7168, v22
  v_lshlrev_b32 v10, 1, v1
  v_lshrrev_b32 v11, 5, v1
  v_lshl_add_u32 v10, v11, 16, v10
  s_lshl_b32 s10, s9, 7
  s_cmp_eq_u32 s7, 0
  s_cselect_b32 s10, s10, 0x10000
  buffer_load_ushort v32, v10, s[48:51], s10 offen
  buffer_load_ushort v36, v10, s[48:51], s10 offen offset:64
  v_mov_b32 v33, 0
  v_mov_b32 v34, 0
  v_mov_b32 v35, 0
  v_mov_b32 v37, 0
  v_mov_b32 v38, 0
  v_mov_b32 v39, 0
  v_mov_b32 v253, 0
  v_mov_b32 v254, 0
  v_mov_b32 v255, 0
  v_mov_b32 v252, 0x3f80
  s_waitcnt lgkmcnt(0)
  v_sub_f32 v28, 1.0, v28
  v_mov_b32 v29, v28
  v_sub_f32 v31, 1.0, v31
  v_mov_b32 v30, v31
  s_cmp_eq_u32 s9, 7
  s_cbranch_scc1 L_snofin
  s_waitcnt vmcnt(0)
  s_barrier
  s_cmp_lg_u32 s3, 4
  s_cbranch_scc1 L_nohfa
  s_mov_b64 exec, 1
  buffer_store_dwordx2 v[24:25], v15, s[64:67], s78 offen sc1
  s_mov_b64 exec, -1
L_nohfa:
  s_add_u32 s81, s5, 2
  s_and_b32 s81, s81, 7
  s_lshl_b32 s81, s81, 15
  s_add_u32 s81, s81, s85
  s_add_u32 m0, s85, 65536
  s_nop 0
  buffer_load_dwordx4 v2, s[64:67], s81 offen offset:0 sc1 lds
  buffer_load_dwordx4 v2, s[64:67], s81 offen offset:1024 sc1 lds
  buffer_load_dwordx4 v2, s[64:67], s81 offen offset:2048 sc1 lds
  buffer_load_dwordx4 v2, s[64:67], s81 offen offset:3072 sc1 lds
  s_add_u32 m0, s85, 69632
  s_add_u32 s81, s81, 4096
  buffer_load_dwordx4 v2, s[64:67], s81 offen offset:0 sc1 lds
  buffer_load_dwordx4 v2, s[64:67], s81 offen offset:1024 sc1 lds
  buffer_load_dwordx4 v2, s[64:67], s81 offen offset:2048 sc1 lds
  buffer_load_dwordx4 v2, s[64:67], s81 offen offset:3072 sc1 lds
  v_mfma_f32_32x32x16_bf16 v[184:199], v[32:35], v[252:255], 0
  v_mfma_f32_32x32x16_bf16 v[144:159], v[32:35], v[252:255], 0
  v_mfma_f32_32x32x16_bf16 v[200:215], v[36:39], v[252:255], 0
  v_mfma_f32_32x32x16_bf16 v[160:175], v[36:39], v[252:255], 0
  s_add_u32 m0, s84, 0
  s_add_u32 s10, s13, 0
  buffer_load_dwordx4 v22, s[44:47], s10 offen lds
  s_add_u32 m0, s84, 1024
  s_nop 0
  buffer_load_dwordx4 v9, s[44:47], s10 offen lds
  s_add_u32 m0, s84, 2048
  s_add_u32 s10, s13, 14336
  buffer_load_dwordx4 v22, s[44:47], s10 offen lds
  s_add_u32 m0, s84, 3072
  s_nop 0
  buffer_load_dwordx4 v9, s[44:47], s10 offen lds
  s_add_u32 m0, s84, 4096
  s_add_u32 s10, s13, 28672
  buffer_load_dwordx4 v22, s[44:47], s10 offen lds
  s_add_u32 m0, s84, 5120
  s_nop 0
  buffer_load_dwordx4 v9, s[44:47], s10 offen lds
  s_add_u32 m0, s84, 6144
  s_add_u32 s10, s13, 43008
  buffer_load_dwordx4 v22, s[44:47], s10 offen lds
  s_add_u32 m0, s84, 7168
  s_nop 0
  buffer_load_dwordx4 v9, s[44:47], s10 offen lds
  s_add_u32 m0, s84, 8192
  s_add_u32 s10, s13, 57344
  buffer_load_dwordx4 v22, s[44:47], s10 offen lds
  s_add_u32 m0, s84, 9216
  s_nop 0
  buffer_load_dwordx4 v9, s[44:47], s10 offen lds
  s_add_u32 m0, s84, 10240
  s_add_u32 s10, s13, 71680
  buffer_load_dwordx4 v22, s[44:47], s10 offen lds
  s_add_u32 m0, s84, 11264
  s_nop 0
  buffer_load_dwordx4 v9, s[44:47], s10 offen lds
  s_add_u32 m0, s84, 12288
  s_add_u32 s10, s13, 86016
  buffer_load_dwordx4 v22, s[44:47], s10 offen lds
  s_add_u32 m0, s84, 13312
  s_nop 0
  buffer_load_dwordx4 v9, s[44:47], s10 offen lds
  s_add_u32 m0, s84, 14336
  s_add_u32 s10, s13, 100352
  buffer_load_dwordx4 v22, s[44:47], s10 offen lds
  s_add_u32 m0, s84, 15360
  s_nop 0
  buffer_load_dwordx4 v9, s[44:47], s10 offen lds
  s_waitcnt vmcnt(16)
  s_barrier
  s_add_u32 s81, s5, 3
  s_and_b32 s81, s81, 7
  s_lshl_b32 s81, s81, 15
  s_add_u32 s81, s81, s85
  s_add_u32 m0, s85, 0
  s_nop 0
  buffer_load_dwordx4 v2, s[64:67], s81 offen offset:0 sc1 lds
  buffer_load_dwordx4 v2, s[64:67], s81 offen offset:1024 sc1 lds
  buffer_load_dwordx4 v2, s[64:67], s81 offen offset:2048 sc1 lds
  buffer_load_dwordx4 v2, s[64:67], s81 offen offset:3072 sc1 lds
  s_add_u32 m0, s85, 4096
  s_add_u32 s81, s81, 4096
  buffer_load_dwordx4 v2, s[64:67], s81 offen offset:0 sc1 lds
  buffer_load_dwordx4 v2, s[64:67], s81 offen offset:1024 sc1 lds
  buffer_load_dwordx4 v2, s[64:67], s81 offen offset:2048 sc1 lds
  buffer_load_dwordx4 v2, s[64:67], s81 offen offset:3072 sc1 lds
  buffer_load_dwordx2 v[26:27], v23, s[64:67], s79 offen sc1
  s_waitcnt vmcnt(0)
  s_mov_b32 s72, 0xffff
  s_mov_b32 s73, 0x0
  s_mov_b32 s80, 0
poll8:
  v_cmp_eq_u64 vcc, v[26:27], v[24:25]
  s_nop 1
  s_and_b64 vcc, vcc, s[72:73]
  s_cmp_eq_u64 vcc, s[72:73]
  s_cbranch_scc1 poll8_ok
  s_sleep 8
  buffer_load_dwordx2 v[26:27], v23, s[64:67], s79 offen sc1
  s_waitcnt vmcnt(0)
  s_add_u32 s80, s80, 1
  s_cmp_lt_u32 s80, 20000000
  s_cbranch_scc1 poll8
poll8_ok:
  buffer_load_dwordx4 v[48:51], v2, s[64:67], s14 offen offset:0 sc1
  buffer_load_dwordx4 v[52:55], v2, s[64:67], s15 offen offset:0 sc1
  buffer_load_dwordx4 v[56:59], v2, s[64:67], s14 offen offset:1024 sc1
  buffer_load_dwordx4 v[60:63], v2, s[64:67], s15 offen offset:1024 sc1
  buffer_load_dwordx4 v[64:67], v2, s[64:67], s14 offen offset:2048 sc1
  buffer_load_dwordx4 v[68:71], v2, s[64:67], s15 offen offset:2048 sc1
  buffer_load_dwordx4 v[72:75], v2, s[64:67], s14 offen offset:3072 sc1
  buffer_load_dwordx4 v[76:79], v2, s[64:67], s15 offen offset:3072 sc1
  s_add_u32 s14, s14, 4096
  s_add_u32 s15, s15, 4096
  buffer_load_dwordx4 v[80:83], v2, s[64:67], s14 offen offset:0 sc1
  buffer_load_dwordx4 v[84:87], v2, s[64:67], s15 offen offset:0 sc1
  buffer_load_dwordx4 v[88:91], v2, s[64:67], s14 offen offset:1024 sc1
  buffer_load_dwordx4 v[92:95], v2, s[64:67], s15 offen offset:1024 sc1
  buffer_load_dwordx4 v[96:99], v2, s[64:67], s14 offen offset:2048 sc1
  buffer_load_dwordx4 v[100:103], v2, s[64:67], s15 offen offset:2048 sc1
  buffer_load_dwordx4 v[104:107], v2, s[64:67], s14 offen offset:3072 sc1
  buffer_load_dwordx4 v[108:111], v2, s[64:67], s15 offen offset:3072 sc1
  s_barrier
  s_add_u32 s81, s5, 4
  s_and_b32 s81, s81, 7
  s_lshl_b32 s81, s81, 15
  s_add_u32 s81, s81, s85
  s_add_u32 m0, s85, 32768
  s_nop 0
  buffer_load_dwordx4 v2, s[64:67], s81 offen offset:0 sc1 lds
  buffer_load_dwordx4 v2, s[64:67], s81 offen offset:1024 sc1 lds
  buffer_load_dwordx4 v2, s[64:67], s81 offen offset:2048 sc1 lds
  buffer_load_dwordx4 v2, s[64:67], s81 offen offset:3072 sc1 lds
  s_add_u32 m0, s85, 36864
  s_add_u32 s81, s81, 4096
  buffer_load_dwordx4 v2, s[64:67], s81 offen offset:0 sc1 lds
  buffer_load_dwordx4 v2, s[64:67], s81 offen offset:1024 sc1 lds
  buffer_load_dwordx4 v2, s[64:67], s81 offen offset:2048 sc1 lds
  buffer_load_dwordx4 v2, s[64:67], s81 offen offset:3072 sc1 lds
  s_waitcnt vmcnt(22)
  ds_read_b64_tr_b16 v[112:113], v7 offset:0
  ds_read_b64_tr_b16 v[114:115], v7 offset:1024
  ds_read_b64_tr_b16 v[116:117], v8 offset:0
  ds_read_b64_tr_b16 v[118:119], v8 offset:1024
  s_waitcnt vmcnt(20)
  ds_read_b64_tr_b16 v[120:121], v7 offset:2048
  ds_read_b64_tr_b16 v[122:123], v7 offset:3072
  ds_read_b64_tr_b16 v[124:125], v8 offset:2048
  ds_read_b64_tr_b16 v[126:127], v8 offset:3072
  s_waitcnt lgkmcnt(4)
  v_mfma_f32_32x32x16_bf16 v[184:199], v[112:115], v[48:51], v[184:199]
  v_mfma_f32_32x32x16_bf16 v[144:159], v[112:115], v[52:55], v[144:159]
  v_mfma_f32_32x32x16_bf16 v[200:215], v[116:119], v[48:51], v[200:215]
  v_mfma_f32_32x32x16_bf16 v[160:175], v[116:119], v[52:55], v[160:175]
  s_add_u32 s14, s14, 4096
  s_add_u32 s15, s15, 4096
  buffer_load_dwordx4 v[48:51], v2, s[64:67], s14 offen offset:0 sc1
  buffer_load_dwordx4 v[52:55], v2, s[64:67], s15 offen offset:0 sc1
  s_add_u32 m0, s84, 0
  s_add_u32 s10, s13, 114688
  buffer_load_dwordx4 v22, s[44:47], s10 offen lds
  s_add_u32 m0, s84, 1024
  s_nop 0
  buffer_load_dwordx4 v9, s[44:47], s10 offen lds
  s_waitcnt vmcnt(22)
  ds_read_b64_tr_b16 v[128:129], v7 offset:4096
  ds_read_b64_tr_b16 v[130:131], v7 offset:5120
  ds_read_b64_tr_b16 v[132:133], v8 offset:4096
  ds_read_b64_tr_b16 v[134:135], v8 offset:5120
  s_waitcnt lgkmcnt(4)
  v_mfma_f32_32x32x16_bf16 v[184:199], v[120:123], v[56:59], v[184:199]
  v_mfma_f32_32x32x16_bf16 v[144:159], v[120:123], v[60:63], v[144:159]
  v_mfma_f32_32x32x16_bf16 v[200:215], v[124:127], v[56:59], v[200:215]
  v_mfma_f32_32x32x16_bf16 v[160:175], v[124:127], v[60:63], v[160:175]
  buffer_load_dwordx4 v[56:59], v2, s[64:67], s14 offen offset:1024 sc1
  buffer_load_dwordx4 v[60:63], v2, s[64:67], s15 offen offset:1024 sc1
  s_add_u32 m0, s84, 2048
  s_add_u32 s10, s13, 129024
  buffer_load_dwordx4 v22, s[44:47], s10 offen lds
  s_add_u32 m0, s84, 3072
  s_nop 0
  buffer_load_dwordx4 v9, s[44:47], s10 offen lds
  s_waitcnt vmcnt(24)
  ds_read_b64_tr_b16 v[112:113], v7 offset:6144
  ds_read_b64_tr_b16 v[114:115], v7 offset:7168
  ds_read_b64_tr_b16 v[116:117], v8 offset:6144
  ds_read_b64_tr_b16 v[118:119], v8 offset:7168
  s_waitcnt lgkmcnt(4)
  v_mfma_f32_32x32x16_bf16 v[184:199], v[128:131], v[64:67], v[184:199]
  v_mfma_f32_32x32x16_bf16 v[144:159], v[128:131], v[68:71], v[144:159]
  v_mfma_f32_32x32x16_bf16 v[200:215], v[132:135], v[64:67], v[200:215]
  v_mfma_f32_32x32x16_bf16 v[160:175], v[132:135], v[68:71], v[160:175]
  buffer_load_dwordx4 v[64:67], v2, s[64:67], s14 offen offset:2048 sc1
  buffer_load_dwordx4 v[68:71], v2, s[64:67], s15 offen offset:2048 sc1
  s_add_u32 m0, s84, 4096
  s_add_u32 s10, s13, 143360
  buffer_load_dwordx4 v22, s[44:47], s10 offen lds
  s_add_u32 m0, s84, 5120
  s_nop 0
  buffer_load_dwordx4 v9, s[44:47], s10 offen lds
  s_waitcnt vmcnt(26)
  ds_read_b64_tr_b16 v[120:121], v7 offset:8192
  ds_read_b64_tr_b16 v[122:123], v7 offset:9216
  ds_read_b64_tr_b16 v[124:125], v8 offset:8192
  ds_read_b64_tr_b16 v[126:127], v8 offset:9216
  s_waitcnt lgkmcnt(4)
  v_mfma_f32_32x32x16_bf16 v[184:199], v[112:115], v[72:75], v[184:199]
  v_mfma_f32_32x32x16_bf16 v[144:159], v[112:115], v[76:79], v[144:159]
  v_mfma_f32_32x32x16_bf16 v[200:215], v[116:119], v[72:75], v[200:215]
  v_mfma_f32_32x32x16_bf16 v[160:175], v[116:119], v[76:79], v[160:175]
  buffer_load_dwordx4 v[72:75], v2, s[64:67], s14 offen offset:3072 sc1
  buffer_load_dwordx4 v[76:79], v2, s[64:67], s15 offen offset:3072 sc1
  s_add_u32 m0, s84, 6144
  s_add_u32 s10, s13, 157696
  buffer_load_dwordx4 v22, s[44:47], s10 offen lds
  s_add_u32 m0, s84, 7168
  s_nop 0
  buffer_load_dwordx4 v9, s[44:47], s10 offen lds
  s_waitcnt vmcnt(16)
  s_barrier
  s_add_u32 s81, s5, 5
  s_and_b32 s81, s81, 7
  s_lshl_b32 s81, s81, 15
  s_add_u32 s81, s81, s85
  s_add_u32 m0, s85, 65536
  s_nop 0
  buffer_load_dwordx4 v2, s[64:67], s81 offen offset:0 sc1 lds
  buffer_load_dwordx4 v2, s[64:67], s81 offen offset:1024 sc1 lds
  buffer_load_dwordx4 v2, s[64:67], s81 offen offset:2048 sc1 lds
  buffer_load_dwordx4 v2, s[64:67], s81 offen offset:3072 sc1 lds
  s_add_u32 m0, s85, 69632
  s_add_u32 s81, s81, 4096
  buffer_load_dwordx4 v2, s[64:67], s81 offen offset:0 sc1 lds
  buffer_load_dwordx4 v2, s[64:67], s81 offen offset:1024 sc1 lds
  buffer_load_dwordx4 v2, s[64:67], s81 offen offset:2048 sc1 lds
  buffer_load_dwordx4 v2, s[64:67], s81 offen offset:3072 sc1 lds
  ds_read_b64_tr_b16 v[128:129], v7 offset:10240
  ds_read_b64_tr_b16 v[130:131], v7 offset:11264
  ds_read_b64_tr_b16 v[132:133], v8 offset:10240
  ds_read_b64_tr_b16 v[134:135], v8 offset:11264
  s_waitcnt lgkmcnt(4)
  v_mfma_f32_32x32x16_bf16 v[184:199], v[120:123], v[80:83], v[184:199]
  v_mfma_f32_32x32x16_bf16 v[144:159], v[120:123], v[84:87], v[144:159]
  v_mfma_f32_32x32x16_bf16 v[200:215], v[124:127], v[80:83], v[200:215]
  v_mfma_f32_32x32x16_bf16 v[160:175], v[124:127], v[84:87], v[160:175]
  s_add_u32 s14, s14, 4096
  s_add_u32 s15, s15, 4096
  buffer_load_dwordx4 v[80:83], v2, s[64:67], s14 offen offset:0 sc1
  buffer_load_dwordx4 v[84:87], v2, s[64:67], s15 offen offset:0 sc1
  s_add_u32 m0, s84, 8192
  s_add_u32 s10, s13, 172032
  buffer_load_dwordx4 v22, s[44:47], s10 offen lds
  s_add_u32 m0, s84, 9216
  s_nop 0
  buffer_load_dwordx4 v9, s[44:47], s10 offen lds
  ds_read_b64_tr_b16 v[112:113], v7 offset:12288
  ds_read_b64_tr_b16 v[114:115], v7 offset:13312
  ds_read_b64_tr_b16 v[116:117], v8 offset:12288
  ds_read_b64_tr_b16 v[118:119], v8 offset:13312
  s_waitcnt lgkmcnt(4)
  v_mfma_f32_32x32x16_bf16 v[184:199], v[128:131], v[88:91], v[184:199]
  v_mfma_f32_32x32x16_bf16 v[144:159], v[128:131], v[92:95], v[144:159]
  v_mfma_f32_32x32x16_bf16 v[200:215], v[132:135], v[88:91], v[200:215]
  v_mfma_f32_32x32x16_bf16 v[160:175], v[132:135], v[92:95], v[160:175]
  buffer_load_dwordx4 v[88:91], v2, s[64:67], s14 offen offset:1024 sc1
  buffer_load_dwordx4 v[92:95], v2, s[64:67], s15 offen offset:1024 sc1
  s_add_u32 m0, s84, 10240
  s_add_u32 s10, s13, 186368
  buffer_load_dwordx4 v22, s[44:47], s10 offen lds
  s_add_u32 m0, s84, 11264
  s_nop 0
  buffer_load_dwordx4 v9, s[44:47], s10 offen lds
  ds_read_b64_tr_b16 v[120:121], v7 offset:14336
  ds_read_b64_tr_b16 v[122:123], v7 offset:15360
  ds_read_b64_tr_b16 v[124:125], v8 offset:14336
  ds_read_b64_tr_b16 v[126:127], v8 offset:15360
  s_waitcnt lgkmcnt(4)
  v_mfma_f32_32x32x16_bf16 v[184:199], v[112:115], v[96:99], v[184:199]
  v_mfma_f32_32x32x16_bf16 v[144:159], v[112:115], v[100:103], v[144:159]
  v_mfma_f32_32x32x16_bf16 v[200:215], v[116:119], v[96:99], v[200:215]
  v_mfma_f32_32x32x16_bf16 v[160:175], v[116:119], v[100:103], v[160:175]
  buffer_load_dwordx4 v[96:99], v2, s[64:67], s14 offen offset:2048 sc1
  buffer_load_dwordx4 v[100:103], v2, s[64:67], s15 offen offset:2048 sc1
  s_add_u32 m0, s84, 12288
  s_add_u32 s10, s13, 200704
  buffer_load_dwordx4 v22, s[44:47], s10 offen lds
  s_add_u32 m0, s84, 13312
  s_nop 0
  buffer_load_dwordx4 v9, s[44:47], s10 offen lds
  s_waitcnt vmcnt(32)
  ds_read_b64_tr_b16 v[128:129], v7 offset:0
  ds_read_b64_tr_b16 v[130:131], v7 offset:1024
  ds_read_b64_tr_b16 v[132:133], v8 offset:0
  ds_read_b64_tr_b16 v[134:135], v8 offset:1024
  s_waitcnt lgkmcnt(4)
  v_mfma_f32_32x32x16_bf16 v[184:199], v[120:123], v[104:107], v[184:199]
  v_mfma_f32_32x32x16_bf16 v[144:159], v[120:123], v[108:111], v[144:159]
  v_mfma_f32_32x32x16_bf16 v[200:215], v[124:127], v[104:107], v[200:215]
  v_mfma_f32_32x32x16_bf16 v[160:175], v[124:127], v[108:111], v[160:175]
  buffer_load_dwordx4 v[104:107], v2, s[64:67], s14 offen offset:3072 sc1
  buffer_load_dwordx4 v[108:111], v2, s[64:67], s15 offen offset:3072 sc1
  s_add_u32 m0, s84, 14336
  s_add_u32 s10, s13, 215040
  buffer_load_dwordx4 v22, s[44:47], s10 offen lds
  s_add_u32 m0, s84, 15360
  s_nop 0
  buffer_load_dwordx4 v9, s[44:47], s10 offen lds
  s_waitcnt vmcnt(16)
  s_barrier
  s_add_u32 s81, s5, 6
  s_and_b32 s81, s81, 7
  s_lshl_b32 s81, s81, 15
  s_add_u32 s81, s81, s85
  s_add_u32 m0, s85, 0
  s_nop 0
  buffer_load_dwordx4 v2, s[64:67], s81 offen offset:0 sc1 lds
  buffer_load_dwordx4 v2, s[64:67], s81 offen offset:1024 sc1 lds
  buffer_load_dwordx4 v2, s[64:67], s81 offen offset:2048 sc1 lds
  buffer_load_dwordx4 v2, s[64:67], s81 offen offset:3072 sc1 lds
  s_add_u32 m0, s85, 4096
  s_add_u32 s81, s81, 4096
  buffer_load_dwordx4 v2, s[64:67], s81 offen offset:0 sc1 lds
  buffer_load_dwordx4 v2, s[64:67], s81 offen offset:1024 sc1 lds
  buffer_load_dwordx4 v2, s[64:67], s81 offen offset:2048 sc1 lds
  buffer_load_dwordx4 v2, s[64:67], s81 offen offset:3072 sc1 lds
  ds_read_b64_tr_b16 v[112:113], v7 offset:2048
  ds_read_b64_tr_b16 v[114:115], v7 offset:3072
  ds_read_b64_tr_b16 v[116:117], v8 offset:2048
  ds_read_b64_tr_b16 v[118:119], v8 offset:3072
  s_waitcnt lgkmcnt(4)
  v_mfma_f32_32x32x16_bf16 v[184:199], v[128:131], v[48:51], v[184:199]
  v_mfma_f32_32x32x16_bf16 v[144:159], v[128:131], v[52:55], v[144:159]
  v_mfma_f32_32x32x16_bf16 v[200:215], v[132:135], v[48:51], v[200:215]
  v_mfma_f32_32x32x16_bf16 v[160:175], v[132:135], v[52:55], v[160:175]
  s_add_u32 s14, s14, 4096
  s_add_u32 s15, s15, 4096
  buffer_load_dwordx4 v[48:51], v2, s[64:67], s14 offen offset:0 sc1
  buffer_load_dwordx4 v[52:55], v2, s[64:67], s15 offen offset:0 sc1
  s_add_u32 m0, s84, 0
  s_add_u32 s10, s13, 229376
  buffer_load_dwordx4 v22, s[44:47], s10 offen lds
  s_add_u32 m0, s84, 1024
  s_nop 0
  buffer_load_dwordx4 v9, s[44:47], s10 offen lds
  ds_read_b64_tr_b16 v[120:121], v7 offset:4096
  ds_read_b64_tr_b16 v[122:123], v7 offset:5120
  ds_read_b64_tr_b16 v[124:125], v8 offset:4096
  ds_read_b64_tr_b16 v[126:127], v8 offset:5120
  s_waitcnt lgkmcnt(4)
  v_mfma_f32_32x32x16_bf16 v[184:199], v[112:115], v[56:59], v[184:199]
  v_mfma_f32_32x32x16_bf16 v[144:159], v[112:115], v[60:63], v[144:159]
  v_mfma_f32_32x32x16_bf16 v[200:215], v[116:119], v[56:59], v[200:215]
  v_mfma_f32_32x32x16_bf16 v[160:175], v[116:119], v[60:63], v[160:175]
  buffer_load_dwordx4 v[56:59], v2, s[64:67], s14 offen offset:1024 sc1
  buffer_load_dwordx4 v[60:63], v2, s[64:67], s15 offen offset:1024 sc1
  s_add_u32 m0, s84, 2048
  s_add_u32 s10, s13, 243712
  buffer_load_dwordx4 v22, s[44:47], s10 offen lds
  s_add_u32 m0, s84, 3072
  s_nop 0
  buffer_load_dwordx4 v9, s[44:47], s10 offen lds
  ds_read_b64_tr_b16 v[128:129], v7 offset:6144
  ds_read_b64_tr_b16 v[130:131], v7 offset:7168
  ds_read_b64_tr_b16 v[132:133], v8 offset:6144
  ds_read_b64_tr_b16 v[134:135], v8 offset:7168
  s_waitcnt lgkmcnt(4)
  v_mfma_f32_32x32x16_bf16 v[184:199], v[120:123], v[64:67], v[184:199]
  v_mfma_f32_32x32x16_bf16 v[144:159], v[120:123], v[68:71], v[144:159]
  v_mfma_f32_32x32x16_bf16 v[200:215], v[124:127], v[64:67], v[200:215]
  v_mfma_f32_32x32x16_bf16 v[160:175], v[124:127], v[68:71], v[160:175]
  buffer_load_dwordx4 v[64:67], v2, s[64:67], s14 offen offset:2048 sc1
  buffer_load_dwordx4 v[68:71], v2, s[64:67], s15 offen offset:2048 sc1
  s_add_u32 m0, s84, 4096
  s_add_u32 s10, s13, 258048
  buffer_load_dwordx4 v22, s[44:47], s10 offen lds
  s_add_u32 m0, s84, 5120
  s_nop 0
  buffer_load_dwordx4 v9, s[44:47], s10 offen lds
  s_waitcnt vmcnt(32)
  ds_read_b64_tr_b16 v[112:113], v7 offset:8192
  ds_read_b64_tr_b16 v[114:115], v7 offset:9216
  ds_read_b64_tr_b16 v[116:117], v8 offset:8192
  ds_read_b64_tr_b16 v[118:119], v8 offset:9216
  s_waitcnt lgkmcnt(4)
  v_mfma_f32_32x32x16_bf16 v[184:199], v[128:131], v[72:75], v[184:199]
  v_mfma_f32_32x32x16_bf16 v[144:159], v[128:131], v[76:79], v[144:159]
  v_mfma_f32_32x32x16_bf16 v[200:215], v[132:135], v[72:75], v[200:215]
  v_mfma_f32_32x32x16_bf16 v[160:175], v[132:135], v[76:79], v[160:175]
  buffer_load_dwordx4 v[72:75], v2, s[64:67], s14 offen offset:3072 sc1
  buffer_load_dwordx4 v[76:79], v2, s[64:67], s15 offen offset:3072 sc1
  s_add_u32 m0, s84, 6144
  s_add_u32 s10, s13, 272384
  buffer_load_dwordx4 v22, s[44:47], s10 offen lds
  s_add_u32 m0, s84, 7168
  s_nop 0
  buffer_load_dwordx4 v9, s[44:47], s10 offen lds
  s_waitcnt vmcnt(16)
  s_barrier
  s_add_u32 s81, s5, 7
  s_and_b32 s81, s81, 7
  s_lshl_b32 s81, s81, 15
  s_add_u32 s81, s81, s85
  s_add_u32 m0, s85, 32768
  s_nop 0
  buffer_load_dwordx4 v2, s[64:67], s81 offen offset:0 sc1 lds
  buffer_load_dwordx4 v2, s[64:67], s81 offen offset:1024 sc1 lds
  buffer_load_dwordx4 v2, s[64:67], s81 offen offset:2048 sc1 lds
  buffer_load_dwordx4 v2, s[64:67], s81 offen offset:3072 sc1 lds
  s_add_u32 m0, s85, 36864
  s_add_u32 s81, s81, 4096
  buffer_load_dwordx4 v2, s[64:67], s81 offen offset:0 sc1 lds
  buffer_load_dwordx4 v2, s[64:67], s81 offen offset:1024 sc1 lds
  buffer_load_dwordx4 v2, s[64:67], s81 offen offset:2048 sc1 lds
  buffer_load_dwordx4 v2, s[64:67], s81 offen offset:3072 sc1 lds
  ds_read_b64_tr_b16 v[120:121], v7 offset:10240
  ds_read_b64_tr_b16 v[122:123], v7 offset:11264
  ds_read_b64_tr_b16 v[124:125], v8 offset:10240
  ds_read_b64_tr_b16 v[126:127], v8 offset:11264
  s_waitcnt lgkmcnt(4)
  v_mfma_f32_32x32x16_bf16 v[184:199], v[112:115], v[80:83], v[184:199]
  v_mfma_f32_32x32x16_bf16 v[144:159], v[112:115], v[84:87], v[144:159]
  v_mfma_f32_32x32x16_bf16 v[200:215], v[116:119], v[80:83], v[200:215]
  v_mfma_f32_32x32x16_bf16 v[160:175], v[116:119], v[84:87], v[160:175]
  s_add_u32 s14, s14, 4096
  s_add_u32 s15, s15, 4096
  buffer_load_dwordx4 v[80:83], v2, s[64:67], s14 offen offset:0 sc1
  buffer_load_dwordx4 v[84:87], v2, s[64:67], s15 offen offset:0 sc1
  s_add_u32 m0, s84, 8192
  s_add_u32 s10, s13, 286720
  buffer_load_dwordx4 v22, s[44:47], s10 offen lds
  s_add_u32 m0, s84, 9216
  s_nop 0
  buffer_load_dwordx4 v9, s[44:47], s10 offen lds
  ds_read_b64_tr_b16 v[128:129], v7 offset:12288
  ds_read_b64_tr_b16 v[130:131], v7 offset:13312
  ds_read_b64_tr_b16 v[132:133], v8 offset:12288
  ds_read_b64_tr_b16 v[134:135], v8 offset:13312
  s_waitcnt lgkmcnt(4)
  v_mfma_f32_32x32x16_bf16 v[184:199], v[120:123], v[88:91], v[184:199]
  v_mfma_f32_32x32x16_bf16 v[144:159], v[120:123], v[92:95], v[144:159]
  v_mfma_f32_32x32x16_bf16 v[200:215], v[124:127], v[88:91], v[200:215]
  v_mfma_f32_32x32x16_bf16 v[160:175], v[124:127], v[92:95], v[160:175]
  buffer_load_dwordx4 v[88:91], v2, s[64:67], s14 offen offset:1024 sc1
  buffer_load_dwordx4 v[92:95], v2, s[64:67], s15 offen offset:1024 sc1
  s_add_u32 m0, s84, 10240
  s_add_u32 s10, s13, 301056
  buffer_load_dwordx4 v22, s[44:47], s10 offen lds
  s_add_u32 m0, s84, 11264
  s_nop 0
  buffer_load_dwordx4 v9, s[44:47], s10 offen lds
  ds_read_b64_tr_b16 v[112:113], v7 offset:14336
  ds_read_b64_tr_b16 v[114:115], v7 offset:15360
  ds_read_b64_tr_b16 v[116:117], v8 offset:14336
  ds_read_b64_tr_b16 v[118:119], v8 offset:15360
  s_waitcnt lgkmcnt(4)
  v_mfma_f32_32x32x16_bf16 v[184:199], v[128:131], v[96:99], v[184:199]
  v_mfma_f32_32x32x16_bf16 v[144:159], v[128:131], v[100:103], v[144:159]
  v_mfma_f32_32x32x16_bf16 v[200:215], v[132:135], v[96:99], v[200:215]
  v_mfma_f32_32x32x16_bf16 v[160:175], v[132:135], v[100:103], v[160:175]
  buffer_load_dwordx4 v[96:99], v2, s[64:67], s14 offen offset:2048 sc1
  buffer_load_dwordx4 v[100:103], v2, s[64:67], s15 offen offset:2048 sc1
  s_add_u32 m0, s84, 12288
  s_add_u32 s10, s13, 315392
  buffer_load_dwordx4 v22, s[44:47], s10 offen lds
  s_add_u32 m0, s84, 13312
  s_nop 0
  buffer_load_dwordx4 v9, s[44:47], s10 offen lds
  s_waitcnt vmcnt(32)
  ds_read_b64_tr_b16 v[120:121], v7 offset:0
  ds_read_b64_tr_b16 v[122:123], v7 offset:1024
  ds_read_b64_tr_b16 v[124:125], v8 offset:0
  ds_read_b64_tr_b16 v[126:127], v8 offset:1024
  s_waitcnt lgkmcnt(4)
  v_mfma_f32_32x32x16_bf16 v[184:199], v[112:115], v[104:107], v[184:199]
  v_mfma_f32_32x32x16_bf16 v[144:159], v[112:115], v[108:111], v[144:159]
  v_mfma_f32_32x32x16_bf16 v[200:215], v[116:119], v[104:107], v[200:215]
  v_mfma_f32_32x32x16_bf16 v[160:175], v[116:119], v[108:111], v[160:175]
  buffer_load_dwordx4 v[104:107], v2, s[64:67], s14 offen offset:3072 sc1
  buffer_load_dwordx4 v[108:111], v2, s[64:67], s15 offen offset:3072 sc1
  s_add_u32 m0, s84, 14336
  s_add_u32 s10, s13, 329728
  buffer_load_dwordx4 v22, s[44:47], s10 offen lds
  s_add_u32 m0, s84, 15360
  s_nop 0
  buffer_load_dwordx4 v9, s[44:47], s10 offen lds
  s_waitcnt vmcnt(16)
  s_barrier
  s_mul_i32 s10, s7, 100352
  s_add_u32 s10, s10, 0
  s_lshl_b32 s11, s7, 12
  s_add_u32 m0, s11, 65536
  s_nop 0
  buffer_load_dwordx4 v22, s[32:35], s10 offen lds
  s_add_u32 m0, s11, 66560
  s_add_u32 s10, s10, 7168
  buffer_load_dwordx4 v22, s[32:35], s10 offen lds
  s_add_u32 m0, s11, 67584
  s_add_u32 s10, s10, 7168
  buffer_load_dwordx4 v22, s[32:35], s10 offen lds
  s_add_u32 m0, s11, 68608
  s_add_u32 s10, s10, 7168
  buffer_load_dwordx4 v22, s[32:35], s10 offen lds
  s_mul_i32 s10, s7, 100352
  s_add_u32 s10, s10, 25088
  s_lshl_b32 s11, s7, 12
  s_add_u32 m0, s11, 81920
  s_nop 0
  buffer_load_dwordx4 v22, s[32:35], s10 offen lds
  s_add_u32 m0, s11, 82944
  s_add_u32 s10, s10, 7168
  buffer_load_dwordx4 v22, s[32:35], s10 offen lds
  s_add_u32 m0, s11, 83968
  s_add_u32 s10, s10, 7168
  buffer_load_dwordx4 v22, s[32:35], s10 offen lds
  s_add_u32 m0, s11, 84992
  s_add_u32 s10, s10, 7168
  buffer_load_dwordx4 v22, s[32:35], s10 offen lds
  ds_read_b64_tr_b16 v[128:129], v7 offset:2048
  ds_read_b64_tr_b16 v[130:131], v7 offset:3072
  ds_read_b64_tr_b16 v[132:133], v8 offset:2048
  ds_read_b64_tr_b16 v[134:135], v8 offset:3072
  s_waitcnt lgkmcnt(4)
  v_mfma_f32_32x32x16_bf16 v[184:199], v[120:123], v[48:51], v[184:199]
  v_mfma_f32_32x32x16_bf16 v[144:159], v[120:123], v[52:55], v[144:159]
  v_mfma_f32_32x32x16_bf16 v[200:215], v[124:127], v[48:51], v[200:215]
  v_mfma_f32_32x32x16_bf16 v[160:175], v[124:127], v[52:55], v[160:175]
  s_add_u32 s14, s14, 4096
  s_add_u32 s15, s15, 4096
  buffer_load_dwordx4 v[48:51], v2, s[64:67], s14 offen offset:0 sc1
  buffer_load_dwordx4 v[52:55], v2, s[64:67], s15 offen offset:0 sc1
  s_add_u32 m0, s84, 0
  s_add_u32 s10, s13, 344064
  buffer_load_dwordx4 v22, s[44:47], s10 offen lds
  s_add_u32 m0, s84, 1024
  s_nop 0
  buffer_load_dwordx4 v9, s[44:47], s10 offen lds
  ds_read_b64_tr_b16 v[112:113], v7 offset:4096
  ds_read_b64_tr_b16 v[114:115], v7 offset:5120
  ds_read_b64_tr_b16 v[116:117], v8 offset:4096
  ds_read_b64_tr_b16 v[118:119], v8 offset:5120
  s_waitcnt lgkmcnt(4)
  v_mfma_f32_32x32x16_bf16 v[184:199], v[128:131], v[56:59], v[184:199]
  v_mfma_f32_32x32x16_bf16 v[144:159], v[128:131], v[60:63], v[144:159]
  v_mfma_f32_32x32x16_bf16 v[200:215], v[132:135], v[56:59], v[200:215]
  v_mfma_f32_32x32x16_bf16 v[160:175], v[132:135], v[60:63], v[160:175]
  buffer_load_dwordx4 v[56:59], v2, s[64:67], s14 offen offset:1024 sc1
  buffer_load_dwordx4 v[60:63], v2, s[64:67], s15 offen offset:1024 sc1
  s_add_u32 m0, s84, 2048
  s_add_u32 s10, s13, 358400
  buffer_load_dwordx4 v22, s[44:47], s10 offen lds
  s_add_u32 m0, s84, 3072
  s_nop 0
  buffer_load_dwordx4 v9, s[44:47], s10 offen lds
  ds_read_b64_tr_b16 v[120:121], v7 offset:6144
  ds_read_b64_tr_b16 v[122:123], v7 offset:7168
  ds_read_b64_tr_b16 v[124:125], v8 offset:6144
  ds_read_b64_tr_b16 v[126:127], v8 offset:7168
  s_waitcnt lgkmcnt(4)
  v_mfma_f32_32x32x16_bf16 v[184:199], v[112:115], v[64:67], v[184:199]
  v_mfma_f32_32x32x16_bf16 v[144:159], v[112:115], v[68:71], v[144:159]
  v_mfma_f32_32x32x16_bf16 v[200:215], v[116:119], v[64:67], v[200:215]
  v_mfma_f32_32x32x16_bf16 v[160:175], v[116:119], v[68:71], v[160:175]
  buffer_load_dwordx4 v[64:67], v2, s[64:67], s14 offen offset:2048 sc1
  buffer_load_dwordx4 v[68:71], v2, s[64:67], s15 offen offset:2048 sc1
  s_add_u32 m0, s84, 4096
  s_add_u32 s10, s13, 372736
  buffer_load_dwordx4 v22, s[44:47], s10 offen lds
  s_add_u32 m0, s84, 5120
  s_nop 0
  buffer_load_dwordx4 v9, s[44:47], s10 offen lds
  s_waitcnt vmcnt(32)
  ds_read_b64_tr_b16 v[128:129], v7 offset:8192
  ds_read_b64_tr_b16 v[130:131], v7 offset:9216
  ds_read_b64_tr_b16 v[132:133], v8 offset:8192
  ds_read_b64_tr_b16 v[134:135], v8 offset:9216
  s_waitcnt lgkmcnt(4)
  v_mfma_f32_32x32x16_bf16 v[184:199], v[120:123], v[72:75], v[184:199]
  v_mfma_f32_32x32x16_bf16 v[144:159], v[120:123], v[76:79], v[144:159]
  v_mfma_f32_32x32x16_bf16 v[200:215], v[124:127], v[72:75], v[200:215]
  v_mfma_f32_32x32x16_bf16 v[160:175], v[124:127], v[76:79], v[160:175]
  buffer_load_dwordx4 v[72:75], v2, s[64:67], s14 offen offset:3072 sc1
  buffer_load_dwordx4 v[76:79], v2, s[64:67], s15 offen offset:3072 sc1
  s_add_u32 m0, s84, 6144
  s_add_u32 s10, s13, 387072
  buffer_load_dwordx4 v22, s[44:47], s10 offen lds
  s_add_u32 m0, s84, 7168
  s_nop 0
  buffer_load_dwordx4 v9, s[44:47], s10 offen lds
  s_barrier
  s_mul_i32 s10, s7, 100352
  s_add_u32 s10, s10, 50176
  s_lshl_b32 s11, s7, 12
  s_add_u32 m0, s11, 0
  s_nop 0
  buffer_load_dwordx4 v22, s[32:35], s10 offen lds
  s_add_u32 m0, s11, 1024
  s_add_u32 s10, s10, 7168
  buffer_load_dwordx4 v22, s[32:35], s10 offen lds
  s_add_u32 m0, s11, 2048
  s_add_u32 s10, s10, 7168
  buffer_load_dwordx4 v22, s[32:35], s10 offen lds
  s_add_u32 m0, s11, 3072
  s_add_u32 s10, s10, 7168
  buffer_load_dwordx4 v22, s[32:35], s10 offen lds
  s_mul_i32 s10, s7, 100352
  s_add_u32 s10, s10, 75264
  s_lshl_b32 s11, s7, 12
  s_add_u32 m0, s11, 16384
  s_nop 0
  buffer_load_dwordx4 v22, s[32:35], s10 offen lds
  s_add_u32 m0, s11, 17408
  s_add_u32 s10, s10, 7168
  buffer_load_dwordx4 v22, s[32:35], s10 offen lds
  s_add_u32 m0, s11, 18432
  s_add_u32 s10, s10, 7168
  buffer_load_dwordx4 v22, s[32:35], s10 offen lds
  s_add_u32 m0, s11, 19456
  s_add_u32 s10, s10, 7168
  buffer_load_dwordx4 v22, s[32:35], s10 offen lds
  s_waitcnt vmcnt(40)
  ds_read_b64_tr_b16 v[112:113], v7 offset:10240
  ds_read_b64_tr_b16 v[114:115], v7 offset:11264
  ds_read_b64_tr_b16 v[116:117], v8 offset:10240
  ds_read_b64_tr_b16 v[118:119], v8 offset:11264
  s_waitcnt lgkmcnt(4)
  v_mfma_f32_32x32x16_bf16 v[184:199], v[128:131], v[80:83], v[184:199]
  v_mfma_f32_32x32x16_bf16 v[144:159], v[128:131], v[84:87], v[144:159]
  v_mfma_f32_32x32x16_bf16 v[200:215], v[132:135], v[80:83], v[200:215]
  v_mfma_f32_32x32x16_bf16 v[160:175], v[132:135], v[84:87], v[160:175]
  s_waitcnt vmcnt(36)
  ds_read_b64_tr_b16 v[120:121], v7 offset:12288
  ds_read_b64_tr_b16 v[122:123], v7 offset:13312
  ds_read_b64_tr_b16 v[124:125], v8 offset:12288
  ds_read_b64_tr_b16 v[126:127], v8 offset:13312
  s_waitcnt lgkmcnt(4)
  v_mfma_f32_32x32x16_bf16 v[184:199], v[112:115], v[88:91], v[184:199]
  v_mfma_f32_32x32x16_bf16 v[144:159], v[112:115], v[92:95], v[144:159]
  v_mfma_f32_32x32x16_bf16 v[200:215], v[116:119], v[88:91], v[200:215]
  v_mfma_f32_32x32x16_bf16 v[160:175], v[116:119], v[92:95], v[160:175]
  s_waitcnt vmcnt(32)
  ds_read_b64_tr_b16 v[128:129], v7 offset:14336
  ds_read_b64_tr_b16 v[130:131], v7 offset:15360
  ds_read_b64_tr_b16 v[132:133], v8 offset:14336
  ds_read_b64_tr_b16 v[134:135], v8 offset:15360
  s_waitcnt lgkmcnt(4)
  v_mfma_f32_32x32x16_bf16 v[184:199], v[120:123], v[96:99], v[184:199]
  v_mfma_f32_32x32x16_bf16 v[144:159], v[120:123], v[100:103], v[144:159]
  v_mfma_f32_32x32x16_bf16 v[200:215], v[124:127], v[96:99], v[200:215]
  v_mfma_f32_32x32x16_bf16 v[160:175], v[124:127], v[100:103], v[160:175]
  s_waitcnt vmcnt(20)
  ds_read_b64_tr_b16 v[112:113], v7 offset:0
  ds_read_b64_tr_b16 v[114:115], v7 offset:1024
  ds_read_b64_tr_b16 v[116:117], v8 offset:0
  ds_read_b64_tr_b16 v[118:119], v8 offset:1024
  s_waitcnt lgkmcnt(4)
  v_mfma_f32_32x32x16_bf16 v[184:199], v[128:131], v[104:107], v[184:199]
  v_mfma_f32_32x32x16_bf16 v[144:159], v[128:131], v[108:111], v[144:159]
  v_mfma_f32_32x32x16_bf16 v[200:215], v[132:135], v[104:107], v[200:215]
  v_mfma_f32_32x32x16_bf16 v[160:175], v[132:135], v[108:111], v[160:175]
  s_lshl_b32 s10, s82, 1
  s_and_b32 s11, s3, 1
  s_add_u32 s76, s10, s11
  s_lshr_b32 s79, s3, 1
  s_lshl_b32 s10, s76, 2
  s_add_u32 s10, s10, s79
  s_lshl_b32 s77, s10, 13
  s_add_u32 s77, s77, s68
  s_add_u32 s77, s77, 524288
  s_add_u32 s78, s77, 4096
  s_lshl_b32 s12, s11, 14
  s_add_u32 s12, s12, 98304
  v_add_u32 v14, s12, v2
  v_xor_b32 v19, 0x4000, v14
  s_mul_i32 s11, s11, 6144
  v_add_u32 v13, s11, v2
  s_lshl_b32 s10, s4, 2
  s_add_u32 s10, s10, s76
  s_lshl_b32 s10, s10, 5
  v_lshrrev_b32 v18, 5, v1
  v_and_b32 v16, 31, v1
  v_add_u32 v16, s10, v16
  v_mul_u32_u24 v16, 896, v16
  v_lshl_add_u32 v16, v18, 4, v16
  s_lshl_b32 s81, s9, 7
  s_lshl_b32 s11, s79, 5
  s_add_u32 s81, s81, s11
  v_add_u32 v12, 65536, v21
  v_add_u32 v17, 65536, v20
  s_waitcnt vmcnt(0)
  s_barrier
  ds_read_b64_tr_b16 v[120:121], v7 offset:2048
  ds_read_b64_tr_b16 v[122:123], v7 offset:3072
  ds_read_b64_tr_b16 v[124:125], v8 offset:2048
  ds_read_b64_tr_b16 v[126:127], v8 offset:3072
  s_waitcnt lgkmcnt(4)
  v_mfma_f32_32x32x16_bf16 v[184:199], v[112:115], v[48:51], v[184:199]
  v_mfma_f32_32x32x16_bf16 v[144:159], v[112:115], v[52:55], v[144:159]
  v_mfma_f32_32x32x16_bf16 v[200:215], v[116:119], v[48:51], v[200:215]
  v_mfma_f32_32x32x16_bf16 v[160:175], v[116:119], v[52:55], v[160:175]
  ds_read_b64_tr_b16 v[128:129], v7 offset:4096
  ds_read_b64_tr_b16 v[130:131], v7 offset:5120
  ds_read_b64_tr_b16 v[132:133], v8 offset:4096
  ds_read_b64_tr_b16 v[134:135], v8 offset:5120
  s_waitcnt lgkmcnt(4)
  v_mfma_f32_32x32x16_bf16 v[184:199], v[120:123], v[56:59], v[184:199]
  v_mfma_f32_32x32x16_bf16 v[144:159], v[120:123], v[60:63], v[144:159]
  v_mfma_f32_32x32x16_bf16 v[200:215], v[124:127], v[56:59], v[200:215]
  v_mfma_f32_32x32x16_bf16 v[160:175], v[124:127], v[60:63], v[160:175]
  ds_read_b64_tr_b16 v[112:113], v7 offset:6144
  ds_read_b64_tr_b16 v[114:115], v7 offset:7168
  ds_read_b64_tr_b16 v[116:117], v8 offset:6144
  ds_read_b64_tr_b16 v[118:119], v8 offset:7168
  s_waitcnt lgkmcnt(4)
  v_mfma_f32_32x32x16_bf16 v[184:199], v[128:131], v[64:67], v[184:199]
  v_mfma_f32_32x32x16_bf16 v[144:159], v[128:131], v[68:71], v[144:159]
  v_mfma_f32_32x32x16_bf16 v[200:215], v[132:135], v[64:67], v[200:215]
  v_mfma_f32_32x32x16_bf16 v[160:175], v[132:135], v[68:71], v[160:175]
  s_waitcnt lgkmcnt(0)
  v_mfma_f32_32x32x16_bf16 v[184:199], v[112:115], v[72:75], v[184:199]
  v_mfma_f32_32x32x16_bf16 v[144:159], v[112:115], v[76:79], v[144:159]
  v_mfma_f32_32x32x16_bf16 v[200:215], v[116:119], v[72:75], v[200:215]
  v_mfma_f32_32x32x16_bf16 v[160:175], v[116:119], v[76:79], v[160:175]
  v_add_u32 v7, s84, v2
  s_nop 10
  v_pk_mul_f32 v[144:145], v[144:145], v[30:31]
  v_pk_mul_f32 v[146:147], v[146:147], v[30:31]
  v_pk_mul_f32 v[148:149], v[148:149], v[30:31]
  v_pk_mul_f32 v[150:151], v[150:151], v[30:31]
  v_pk_mul_f32 v[152:153], v[152:153], v[30:31]
  v_pk_mul_f32 v[154:155], v[154:155], v[30:31]
  v_pk_mul_f32 v[156:157], v[156:157], v[30:31]
  v_pk_mul_f32 v[158:159], v[158:159], v[30:31]
  v_pk_mul_f32 v[160:161], v[160:161], v[30:31]
  v_pk_mul_f32 v[162:163], v[162:163], v[30:31]
  v_pk_mul_f32 v[164:165], v[164:165], v[30:31]
  v_pk_mul_f32 v[166:167], v[166:167], v[30:31]
  v_pk_mul_f32 v[168:169], v[168:169], v[30:31]
  v_pk_mul_f32 v[170:171], v[170:171], v[30:31]
  v_pk_mul_f32 v[172:173], v[172:173], v[30:31]
  v_pk_mul_f32 v[174:175], v[174:175], v[30:31]
  ds_write_b128 v7, v[144:147] offset:6144
  ds_write_b128 v7, v[148:151] offset:7168
  ds_write_b128 v7, v[152:155] offset:8192
  ds_write_b128 v7, v[156:159] offset:9216
  ds_write_b128 v7, v[160:163] offset:10240
  ds_write_b128 v7, v[164:167] offset:11264
  ds_write_b128 v7, v[168:171] offset:12288
  ds_write_b128 v7, v[172:175] offset:13312
  v_pk_mul_f32 v[184:185], v[184:185], v[28:29]
  v_pk_mul_f32 v[186:187], v[186:187], v[28:29]
  v_pk_mul_f32 v[188:189], v[188:189], v[28:29]
  v_pk_mul_f32 v[190:191], v[190:191], v[28:29]
  v_pk_mul_f32 v[192:193], v[192:193], v[28:29]
  v_pk_mul_f32 v[194:195], v[194:195], v[28:29]
  v_pk_mul_f32 v[196:197], v[196:197], v[28:29]
  v_pk_mul_f32 v[198:199], v[198:199], v[28:29]
  v_pk_mul_f32 v[200:201], v[200:201], v[28:29]
  v_pk_mul_f32 v[202:203], v[202:203], v[28:29]
  v_pk_mul_f32 v[204:205], v[204:205], v[28:29]
  v_pk_mul_f32 v[206:207], v[206:207], v[28:29]
  v_pk_mul_f32 v[208:209], v[208:209], v[28:29]
  v_pk_mul_f32 v[210:211], v[210:211], v[28:29]
  v_pk_mul_f32 v[212:213], v[212:213], v[28:29]
  v_pk_mul_f32 v[214:215], v[214:215], v[28:29]
  s_branch L_fin
L_snofin:
  s_waitcnt vmcnt(0)
  s_barrier
  s_cmp_lg_u32 s3, 4
  s_cbranch_scc1 L_nohfb
  s_mov_b64 exec, 1
  buffer_store_dwordx2 v[24:25], v15, s[64:67], s78 offen sc1
  s_mov_b64 exec, -1
L_nohfb:
  s_add_u32 s81, s5, 2
  s_and_b32 s81, s81, 7
  s_lshl_b32 s81, s81, 15
  s_add_u32 s81, s81, s85
  s_add_u32 m0, s85, 65536
  s_nop 0
  buffer_load_dwordx4 v2, s[64:67], s81 offen offset:0 sc1 lds
  buffer_load_dwordx4 v2, s[64:67], s81 offen offset:1024 sc1 lds
  buffer_load_dwordx4 v2, s[64:67], s81 offen offset:2048 sc1 lds
  buffer_load_dwordx4 v2, s[64:67], s81 offen offset:3072 sc1 lds
  s_add_u32 m0, s85, 69632
  s_add_u32 s81, s81, 4096
  buffer_load_dwordx4 v2, s[64:67], s81 offen offset:0 sc1 lds
  buffer_load_dwordx4 v2, s[64:67], s81 offen offset:1024 sc1 lds
  buffer_load_dwordx4 v2, s[64:67], s81 offen offset:2048 sc1 lds
  buffer_load_dwordx4 v2, s[64:67], s81 offen offset:3072 sc1 lds
  s_waitcnt vmcnt(0)
  s_barrier
  s_add_u32 s81, s5, 3
  s_and_b32 s81, s81, 7
  s_lshl_b32 s81, s81, 15
  s_add_u32 s81, s81, s85
  s_add_u32 m0, s85, 0
  s_nop 0
  buffer_load_dwordx4 v2, s[64:67], s81 offen offset:0 sc1 lds
  buffer_load_dwordx4 v2, s[64:67], s81 offen offset:1024 sc1 lds
  buffer_load_dwordx4 v2, s[64:67], s81 offen offset:2048 sc1 lds
  buffer_load_dwordx4 v2, s[64:67], s81 offen offset:3072 sc1 lds
  s_add_u32 m0, s85, 4096
  s_add_u32 s81, s81, 4096
  buffer_load_dwordx4 v2, s[64:67], s81 offen offset:0 sc1 lds
  buffer_load_dwordx4 v2, s[64:67], s81 offen offset:1024 sc1 lds
  buffer_load_dwordx4 v2, s[64:67], s81 offen offset:2048 sc1 lds
  buffer_load_dwordx4 v2, s[64:67], s81 offen offset:3072 sc1 lds
  s_waitcnt vmcnt(0)
  s_barrier
  s_add_u32 s81, s5, 4
  s_and_b32 s81, s81, 7
  s_lshl_b32 s81, s81, 15
  s_add_u32 s81, s81, s85
  s_add_u32 m0, s85, 32768
  s_nop 0
  buffer_load_dwordx4 v2, s[64:67], s81 offen offset:0 sc1 lds
  buffer_load_dwordx4 v2, s[64:67], s81 offen offset:1024 sc1 lds
  buffer_load_dwordx4 v2, s[64:67], s81 offen offset:2048 sc1 lds
  buffer_load_dwordx4 v2, s[64:67], s81 offen offset:3072 sc1 lds
  s_add_u32 m0, s85, 36864
  s_add_u32 s81, s81, 4096
  buffer_load_dwordx4 v2, s[64:67], s81 offen offset:0 sc1 lds
  buffer_load_dwordx4 v2, s[64:67], s81 offen offset:1024 sc1 lds
  buffer_load_dwordx4 v2, s[64:67], s81 offen offset:2048 sc1 lds
  buffer_load_dwordx4 v2, s[64:67], s81 offen offset:3072 sc1 lds
  s_waitcnt vmcnt(0)
  s_barrier
  s_add_u32 s81, s5, 5
  s_and_b32 s81, s81, 7
  s_lshl_b32 s81, s81, 15
  s_add_u32 s81, s81, s85
  s_add_u32 m0, s85, 65536
  s_nop 0
  buffer_load_dwordx4 v2, s[64:67], s81 offen offset:0 sc1 lds
  buffer_load_dwordx4 v2, s[64:67], s81 offen offset:1024 sc1 lds
  buffer_load_dwordx4 v2, s[64:67], s81 offen offset:2048 sc1 lds
  buffer_load_dwordx4 v2, s[64:67], s81 offen offset:3072 sc1 lds
  s_add_u32 m0, s85, 69632
  s_add_u32 s81, s81, 4096
  buffer_load_dwordx4 v2, s[64:67], s81 offen offset:0 sc1 lds
  buffer_load_dwordx4 v2, s[64:67], s81 offen offset:1024 sc1 lds
  buffer_load_dwordx4 v2, s[64:67], s81 offen offset:2048 sc1 lds
  buffer_load_dwordx4 v2, s[64:67], s81 offen offset:3072 sc1 lds
  s_waitcnt vmcnt(0)
  s_barrier
  s_add_u32 s81, s5, 6
  s_and_b32 s81, s81, 7
  s_lshl_b32 s81, s81, 15
  s_add_u32 s81, s81, s85
  s_add_u32 m0, s85, 0
  s_nop 0
  buffer_load_dwordx4 v2, s[64:67], s81 offen offset:0 sc1 lds
  buffer_load_dwordx4 v2, s[64:67], s81 offen offset:1024 sc1 lds
  buffer_load_dwordx4 v2, s[64:67], s81 offen offset:2048 sc1 lds
  buffer_load_dwordx4 v2, s[64:67], s81 offen offset:3072 sc1 lds
  s_add_u32 m0, s85, 4096
  s_add_u32 s81, s81, 4096
  buffer_load_dwordx4 v2, s[64:67], s81 offen offset:0 sc1 lds
  buffer_load_dwordx4 v2, s[64:67], s81 offen offset:1024 sc1 lds
  buffer_load_dwordx4 v2, s[64:67], s81 offen offset:2048 sc1 lds
  buffer_load_dwordx4 v2, s[64:67], s81 offen offset:3072 sc1 lds
  s_waitcnt vmcnt(0)
  s_barrier
  s_add_u32 s81, s5, 7
  s_and_b32 s81, s81, 7
  s_lshl_b32 s81, s81, 15
  s_add_u32 s81, s81, s85
  s_add_u32 m0, s85, 32768
  s_nop 0
  buffer_load_dwordx4 v2, s[64:67], s81 offen offset:0 sc1 lds
  buffer_load_dwordx4 v2, s[64:67], s81 offen offset:1024 sc1 lds
  buffer_load_dwordx4 v2, s[64:67], s81 offen offset:2048 sc1 lds
  buffer_load_dwordx4 v2, s[64:67], s81 offen offset:3072 sc1 lds
  s_add_u32 m0, s85, 36864
  s_add_u32 s81, s81, 4096
  buffer_load_dwordx4 v2, s[64:67], s81 offen offset:0 sc1 lds
  buffer_load_dwordx4 v2, s[64:67], s81 offen offset:1024 sc1 lds
  buffer_load_dwordx4 v2, s[64:67], s81 offen offset:2048 sc1 lds
  buffer_load_dwordx4 v2, s[64:67], s81 offen offset:3072 sc1 lds
  s_waitcnt vmcnt(0)
  s_barrier
  s_waitcnt vmcnt(0)
  s_barrier
  s_branch L_done
L_afin:
  s_mul_i32 s10, s3, 6144
  s_add_u32 s10, s10, 32768
  v_add_u32 v7, s10, v2
  s_lshl_b32 s10, s82, 1
  s_and_b32 s11, s3, 1
  s_add_u32 s76, s10, s11
  s_lshr_b32 s79, s3, 1
  s_lshl_b32 s10, s76, 2
  s_add_u32 s10, s10, s79
  s_lshl_b32 s77, s10, 13
  s_add_u32 s77, s77, s68
  s_add_u32 s77, s77, 524288
  s_add_u32 s78, s77, 4096
  s_lshl_b32 s12, s11, 14
  s_add_u32 s12, s12, 98304
  v_add_u32 v14, s12, v2
  v_xor_b32 v19, 0x4000, v14
  s_mul_i32 s11, s11, 6144
  v_add_u32 v13, s11, v2
  s_lshl_b32 s10, s4, 2
  s_add_u32 s10, s10, s76
  s_lshl_b32 s10, s10, 5
  v_lshrrev_b32 v18, 5, v1
  v_and_b32 v16, 31, v1
  v_add_u32 v16, s10, v16
  v_mul_u32_u24 v16, 896, v16
  v_lshl_add_u32 v16, v18, 4, v16
  s_lshl_b32 s81, s9, 7
  s_lshl_b32 s11, s79, 5
  s_add_u32 s81, s81, s11
  v_add_u32 v12, 65536, v21
  v_add_u32 v17, 65536, v20
  s_barrier
L_fin:
  buffer_load_dwordx4 v[64:67], v2, s[64:67], s77 offen offset:0 sc1
  buffer_load_dwordx4 v[68:71], v2, s[64:67], s77 offen offset:1024 sc1
  buffer_load_dwordx4 v[72:75], v2, s[64:67], s77 offen offset:2048 sc1
  buffer_load_dwordx4 v[76:79], v2, s[64:67], s77 offen offset:3072 sc1
  buffer_load_dwordx4 v[80:83], v2, s[64:67], s78 offen offset:0 sc1
  buffer_load_dwordx4 v[84:87], v2, s[64:67], s78 offen offset:1024 sc1
  buffer_load_dwordx4 v[88:91], v2, s[64:67], s78 offen offset:2048 sc1
  buffer_load_dwordx4 v[92:95], v2, s[64:67], s78 offen offset:3072 sc1
  ds_read_b64_tr_b16 v[120:121], v12 offset:0
  ds_read_b64_tr_b16 v[122:123], v12 offset:1024
  ds_read_b64_tr_b16 v[124:125], v17 offset:0
  ds_read_b64_tr_b16 v[126:127], v17 offset:1024
  ds_read_b64_tr_b16 v[128:129], v12 offset:2048
  ds_read_b64_tr_b16 v[130:131], v12 offset:3072
  ds_read_b64_tr_b16 v[132:133], v17 offset:2048
  ds_read_b64_tr_b16 v[134:135], v17 offset:3072
  ds_read_b64_tr_b16 v[136:137], v12 offset:16384
  ds_read_b64_tr_b16 v[138:139], v12 offset:17408
  ds_read_b64_tr_b16 v[140:141], v17 offset:16384
  ds_read_b64_tr_b16 v[142:143], v17 offset:17408
  ds_read_b64_tr_b16 v[144:145], v12 offset:18432
  ds_read_b64_tr_b16 v[146:147], v12 offset:19456
  ds_read_b64_tr_b16 v[148:149], v17 offset:18432
  ds_read_b64_tr_b16 v[150:151], v17 offset:19456
  ds_read_b64_tr_b16 v[48:49], v21 offset:0
  ds_read_b64_tr_b16 v[50:51], v21 offset:1024
  ds_read_b64_tr_b16 v[52:53], v20 offset:0
  ds_read_b64_tr_b16 v[54:55], v20 offset:1024
  ds_read_b64_tr_b16 v[56:57], v21 offset:2048
  ds_read_b64_tr_b16 v[58:59], v21 offset:3072
  ds_read_b64_tr_b16 v[60:61], v20 offset:2048
  ds_read_b64_tr_b16 v[62:63], v20 offset:3072
  ds_read_b64_tr_b16 v[96:97], v21 offset:16384
  ds_read_b64_tr_b16 v[98:99], v21 offset:17408
  ds_read_b64_tr_b16 v[100:101], v20 offset:16384
  ds_read_b64_tr_b16 v[102:103], v20 offset:17408
  ds_read_b64_tr_b16 v[104:105], v21 offset:18432
  ds_read_b64_tr_b16 v[106:107], v21 offset:19456
  ds_read_b64_tr_b16 v[108:109], v20 offset:18432
  ds_read_b64_tr_b16 v[110:111], v20 offset:19456
  s_waitcnt lgkmcnt(0)
  s_mov_b32 s80, 0
L_otry:
  s_waitcnt vmcnt(7)
  v_mfma_f32_32x32x16_bf16 v[216:231], v[120:123], v[64:67], v[184:199]
  v_mfma_f32_32x32x16_bf16 v[232:247], v[124:127], v[64:67], v[200:215]
  v_max3_u32 v112, v64, v65, v66
  v_max_u32 v112, v112, v67
  s_waitcnt vmcnt(6)
  v_mfma_f32_32x32x16_bf16 v[216:231], v[128:131], v[68:71], v[216:231]
  v_mfma_f32_32x32x16_bf16 v[232:247], v[132:135], v[68:71], v[232:247]
  v_max3_u32 v112, v112, v68, v69
  v_max3_u32 v112, v112, v70, v71
  s_waitcnt vmcnt(5)
  v_mfma_f32_32x32x16_bf16 v[216:231], v[136:139], v[72:75], v[216:231]
  v_mfma_f32_32x32x16_bf16 v[232:247], v[140:143], v[72:75], v[232:247]
  v_max3_u32 v112, v112, v72, v73
  v_max3_u32 v112, v112, v74, v75
  s_waitcnt vmcnt(4)
  v_mfma_f32_32x32x16_bf16 v[216:231], v[144:147], v[76:79], v[216:231]
  v_mfma_f32_32x32x16_bf16 v[232:247], v[148:151], v[76:79], v[232:247]
  v_max3_u32 v112, v112, v76, v77
  v_max3_u32 v112, v112, v78, v79
  s_waitcnt vmcnt(3)
  v_mfma_f32_32x32x16_bf16 v[216:231], v[48:51], v[80:83], v[216:231]
  v_mfma_f32_32x32x16_bf16 v[232:247], v[52:55], v[80:83], v[232:247]
  v_max3_u32 v112, v112, v80, v81
  v_max3_u32 v112, v112, v82, v83
  s_waitcnt vmcnt(2)
  v_mfma_f32_32x32x16_bf16 v[216:231], v[56:59], v[84:87], v[216:231]
  v_mfma_f32_32x32x16_bf16 v[232:247], v[60:63], v[84:87], v[232:247]
  v_max3_u32 v112, v112, v84, v85
  v_max3_u32 v112, v112, v86, v87
  s_waitcnt vmcnt(1)
  v_mfma_f32_32x32x16_bf16 v[216:231], v[96:99], v[88:91], v[216:231]
  v_mfma_f32_32x32x16_bf16 v[232:247], v[100:103], v[88:91], v[232:247]
  v_max3_u32 v112, v112, v88, v89
  v_max3_u32 v112, v112, v90, v91
  s_waitcnt vmcnt(0)
  v_mfma_f32_32x32x16_bf16 v[216:231], v[104:107], v[92:95], v[216:231]
  v_mfma_f32_32x32x16_bf16 v[232:247], v[108:111], v[92:95], v[232:247]
  v_max3_u32 v112, v112, v92, v93
  v_max3_u32 v112, v112, v94, v95
  v_cmp_eq_u32 vcc, -1, v112
  s_nop 1
  s_cbranch_vccz L_ook
  s_add_u32 s80, s80, 1
  s_cmp_lt_u32 s80, 20000000
  s_cbranch_scc0 L_ook
  s_sleep 2
  buffer_load_dwordx4 v[64:67], v2, s[64:67], s77 offen offset:0 sc1
  buffer_load_dwordx4 v[68:71], v2, s[64:67], s77 offen offset:1024 sc1
  buffer_load_dwordx4 v[72:75], v2, s[64:67], s77 offen offset:2048 sc1
  buffer_load_dwordx4 v[76:79], v2, s[64:67], s77 offen offset:3072 sc1
  buffer_load_dwordx4 v[80:83], v2, s[64:67], s78 offen offset:0 sc1
  buffer_load_dwordx4 v[84:87], v2, s[64:67], s78 offen offset:1024 sc1
  buffer_load_dwordx4 v[88:91], v2, s[64:67], s78 offen offset:2048 sc1
  buffer_load_dwordx4 v[92:95], v2, s[64:67], s78 offen offset:3072 sc1
  s_branch L_otry
L_ook:
  s_cmp_eq_u32 s79, 1
  s_cbranch_scc1 L_red1
  s_cmp_eq_u32 s79, 2
  s_cbranch_scc1 L_red2
  s_cmp_eq_u32 s79, 3
  s_cbranch_scc1 L_red3
  s_nop 5
  ds_write_b128 v7, v[224:227] offset:0
  ds_write_b128 v7, v[228:231] offset:1024
  ds_write_b128 v7, v[232:235] offset:2048
  ds_write_b128 v7, v[236:239] offset:3072
  ds_write_b128 v7, v[240:243] offset:4096
  ds_write_b128 v7, v[244:247] offset:5120
  s_waitcnt lgkmcnt(0)
  s_barrier
  ds_read_b128 v[120:123], v13 offset:45056
  ds_read_b128 v[124:127], v13 offset:46080
  ds_read_b128 v[128:131], v14 offset:0
  ds_read_b128 v[132:135], v14 offset:1024
  ds_read_b128 v[136:139], v14 offset:32768
  ds_read_b128 v[140:143], v14 offset:33792
  ds_read_b128 v[144:147], v19 offset:6144
  ds_read_b128 v[148:151], v19 offset:7168
  ds_read_b128 v[152:155], v19 offset:38912
  ds_read_b128 v[156:159], v19 offset:39936
  s_waitcnt lgkmcnt(8)
  v_pk_add_f32 v[64:65], v[216:217], v[120:121]
  v_pk_add_f32 v[66:67], v[218:219], v[122:123]
  v_pk_add_f32 v[68:69], v[220:221], v[124:125]
  v_pk_add_f32 v[70:71], v[222:223], v[126:127]
  s_waitcnt lgkmcnt(6)
  v_pk_add_f32 v[64:65], v[64:65], v[128:129]
  v_pk_add_f32 v[66:67], v[66:67], v[130:131]
  v_pk_add_f32 v[68:69], v[68:69], v[132:133]
  v_pk_add_f32 v[70:71], v[70:71], v[134:135]
  s_waitcnt lgkmcnt(4)
  v_pk_add_f32 v[64:65], v[64:65], v[136:137]
  v_pk_add_f32 v[66:67], v[66:67], v[138:139]
  v_pk_add_f32 v[68:69], v[68:69], v[140:141]
  v_pk_add_f32 v[70:71], v[70:71], v[142:143]
  s_waitcnt lgkmcnt(2)
  v_pk_add_f32 v[64:65], v[64:65], v[144:145]
  v_pk_add_f32 v[66:67], v[66:67], v[146:147]
  v_pk_add_f32 v[68:69], v[68:69], v[148:149]
  v_pk_add_f32 v[70:71], v[70:71], v[150:151]
  s_waitcnt lgkmcnt(0)
  v_pk_add_f32 v[64:65], v[64:65], v[152:153]
  v_pk_add_f32 v[66:67], v[66:67], v[154:155]
  v_pk_add_f32 v[68:69], v[68:69], v[156:157]
  v_pk_add_f32 v[70:71], v[70:71], v[158:159]
  s_branch L_red_done
L_red1:
  s_nop 5
  ds_write_b128 v7, v[216:219] offset:0
  ds_write_b128 v7, v[220:223] offset:1024
  ds_write_b128 v7, v[232:235] offset:2048
  ds_write_b128 v7, v[236:239] offset:3072
  ds_write_b128 v7, v[240:243] offset:4096
  ds_write_b128 v7, v[244:247] offset:5120
  s_waitcnt lgkmcnt(0)
  s_barrier
  ds_read_b128 v[120:123], v13 offset:32768
  ds_read_b128 v[124:127], v13 offset:33792
  ds_read_b128 v[128:131], v14 offset:2048
  ds_read_b128 v[132:135], v14 offset:3072
  ds_read_b128 v[136:139], v14 offset:34816
  ds_read_b128 v[140:143], v14 offset:35840
  ds_read_b128 v[144:147], v19 offset:8192
  ds_read_b128 v[148:151], v19 offset:9216
  ds_read_b128 v[152:155], v19 offset:40960
  ds_read_b128 v[156:159], v19 offset:41984
  s_waitcnt lgkmcnt(8)
  v_pk_add_f32 v[64:65], v[224:225], v[120:121]
  v_pk_add_f32 v[66:67], v[226:227], v[122:123]
  v_pk_add_f32 v[68:69], v[228:229], v[124:125]
  v_pk_add_f32 v[70:71], v[230:231], v[126:127]
  s_waitcnt lgkmcnt(6)
  v_pk_add_f32 v[64:65], v[64:65], v[128:129]
  v_pk_add_f32 v[66:67], v[66:67], v[130:131]
  v_pk_add_f32 v[68:69], v[68:69], v[132:133]
  v_pk_add_f32 v[70:71], v[70:71], v[134:135]
  s_waitcnt lgkmcnt(4)
  v_pk_add_f32 v[64:65], v[64:65], v[136:137]
  v_pk_add_f32 v[66:67], v[66:67], v[138:139]
  v_pk_add_f32 v[68:69], v[68:69], v[140:141]
  v_pk_add_f32 v[70:71], v[70:71], v[142:143]
  s_waitcnt lgkmcnt(2)
  v_pk_add_f32 v[64:65], v[64:65], v[144:145]
  v_pk_add_f32 v[66:67], v[66:67], v[146:147]
  v_pk_add_f32 v[68:69], v[68:69], v[148:149]
  v_pk_add_f32 v[70:71], v[70:71], v[150:151]
  s_waitcnt lgkmcnt(0)
  v_pk_add_f32 v[64:65], v[64:65], v[152:153]
  v_pk_add_f32 v[66:67], v[66:67], v[154:155]
  v_pk_add_f32 v[68:69], v[68:69], v[156:157]
  v_pk_add_f32 v[70:71], v[70:71], v[158:159]
  s_branch L_red_done
L_red2:
  s_nop 5
  ds_write_b128 v7, v[216:219] offset:0
  ds_write_b128 v7, v[220:223] offset:1024
  ds_write_b128 v7, v[224:227] offset:2048
  ds_write_b128 v7, v[228:231] offset:3072
  ds_write_b128 v7, v[240:243] offset:4096
  ds_write_b128 v7, v[244:247] offset:5120
  s_waitcnt lgkmcnt(0)
  s_barrier
  ds_read_b128 v[120:123], v13 offset:34816
  ds_read_b128 v[124:127], v13 offset:35840
  ds_read_b128 v[128:131], v13 offset:47104
  ds_read_b128 v[132:135], v13 offset:48128
  ds_read_b128 v[136:139], v14 offset:36864
  ds_read_b128 v[140:143], v14 offset:37888
  ds_read_b128 v[144:147], v19 offset:10240
  ds_read_b128 v[148:151], v19 offset:11264
  ds_read_b128 v[152:155], v19 offset:43008
  ds_read_b128 v[156:159], v19 offset:44032
  s_waitcnt lgkmcnt(8)
  v_pk_add_f32 v[64:65], v[232:233], v[120:121]
  v_pk_add_f32 v[66:67], v[234:235], v[122:123]
  v_pk_add_f32 v[68:69], v[236:237], v[124:125]
  v_pk_add_f32 v[70:71], v[238:239], v[126:127]
  s_waitcnt lgkmcnt(6)
  v_pk_add_f32 v[64:65], v[64:65], v[128:129]
  v_pk_add_f32 v[66:67], v[66:67], v[130:131]
  v_pk_add_f32 v[68:69], v[68:69], v[132:133]
  v_pk_add_f32 v[70:71], v[70:71], v[134:135]
  s_waitcnt lgkmcnt(4)
  v_pk_add_f32 v[64:65], v[64:65], v[136:137]
  v_pk_add_f32 v[66:67], v[66:67], v[138:139]
  v_pk_add_f32 v[68:69], v[68:69], v[140:141]
  v_pk_add_f32 v[70:71], v[70:71], v[142:143]
  s_waitcnt lgkmcnt(2)
  v_pk_add_f32 v[64:65], v[64:65], v[144:145]
  v_pk_add_f32 v[66:67], v[66:67], v[146:147]
  v_pk_add_f32 v[68:69], v[68:69], v[148:149]
  v_pk_add_f32 v[70:71], v[70:71], v[150:151]
  s_waitcnt lgkmcnt(0)
  v_pk_add_f32 v[64:65], v[64:65], v[152:153]
  v_pk_add_f32 v[66:67], v[66:67], v[154:155]
  v_pk_add_f32 v[68:69], v[68:69], v[156:157]
  v_pk_add_f32 v[70:71], v[70:71], v[158:159]
  s_branch L_red_done
L_red3:
  s_nop 5
  ds_write_b128 v7, v[216:219] offset:0
  ds_write_b128 v7, v[220:223] offset:1024
  ds_write_b128 v7, v[224:227] offset:2048
  ds_write_b128 v7, v[228:231] offset:3072
  ds_write_b128 v7, v[232:235] offset:4096
  ds_write_b128 v7, v[236:239] offset:5120
  s_waitcnt lgkmcnt(0)
  s_barrier
  ds_read_b128 v[120:123], v13 offset:36864
  ds_read_b128 v[124:127], v13 offset:37888
  ds_read_b128 v[128:131], v13 offset:49152
  ds_read_b128 v[132:135], v13 offset:50176
  ds_read_b128 v[136:139], v14 offset:4096
  ds_read_b128 v[140:143], v14 offset:5120
  ds_read_b128 v[144:147], v19 offset:12288
  ds_read_b128 v[148:151], v19 offset:13312
  ds_read_b128 v[152:155], v19 offset:45056
  ds_read_b128 v[156:159], v19 offset:46080
  s_waitcnt lgkmcnt(8)
  v_pk_add_f32 v[64:65], v[240:241], v[120:121]
  v_pk_add_f32 v[66:67], v[242:243], v[122:123]
  v_pk_add_f32 v[68:69], v[244:245], v[124:125]
  v_pk_add_f32 v[70:71], v[246:247], v[126:127]
  s_waitcnt lgkmcnt(6)
  v_pk_add_f32 v[64:65], v[64:65], v[128:129]
  v_pk_add_f32 v[66:67], v[66:67], v[130:131]
  v_pk_add_f32 v[68:69], v[68:69], v[132:133]
  v_pk_add_f32 v[70:71], v[70:71], v[134:135]
  s_waitcnt lgkmcnt(4)
  v_pk_add_f32 v[64:65], v[64:65], v[136:137]
  v_pk_add_f32 v[66:67], v[66:67], v[138:139]
  v_pk_add_f32 v[68:69], v[68:69], v[140:141]
  v_pk_add_f32 v[70:71], v[70:71], v[142:143]
  s_waitcnt lgkmcnt(2)
  v_pk_add_f32 v[64:65], v[64:65], v[144:145]
  v_pk_add_f32 v[66:67], v[66:67], v[146:147]
  v_pk_add_f32 v[68:69], v[68:69], v[148:149]
  v_pk_add_f32 v[70:71], v[70:71], v[150:151]
  s_waitcnt lgkmcnt(0)
  v_pk_add_f32 v[64:65], v[64:65], v[152:153]
  v_pk_add_f32 v[66:67], v[66:67], v[154:155]
  v_pk_add_f32 v[68:69], v[68:69], v[156:157]
  v_pk_add_f32 v[70:71], v[70:71], v[158:159]
L_red_done:
  v_cvt_pk_bf16_f32 v96, v64, v65
  v_cvt_pk_bf16_f32 v97, v66, v67
  v_cvt_pk_bf16_f32 v98, v68, v69
  v_cvt_pk_bf16_f32 v99, v70, v71
  s_nop 1
  v_permlane32_swap_b32 v96, v98
  v_permlane32_swap_b32 v97, v99
  s_nop 0
  buffer_store_dwordx4 v[96:99], v16, s[56:59], s81 offen
L_done:
  s_endpgm
L_slow:
  s_waitcnt vmcnt(0)
  v_mov_b32 v90, 0xff800000
  v_mov_b32 v96, 0
  v_mov_b32 v97, 0
  v_mov_b32 v98, 0
  v_mov_b32 v99, 0
  v_mov_b32 v100, 0
  v_mov_b32 v101, 0
  v_mov_b32 v102, 0
  v_mov_b32 v103, 0
  v_mov_b32 v104, 0
  v_mov_b32 v105, 0
  v_mov_b32 v106, 0
  v_mov_b32 v107, 0
  v_mov_b32 v108, 0
  v_mov_b32 v109, 0
  v_mov_b32 v110, 0
  v_mov_b32 v111, 0
  s_mov_b32 s10, 0
  s_mov_b32 s11, 0
L_slow_loop:
  buffer_load_dwordx4 v[120:123], v2, s[64:67], s10 offen offset:0 sc1
  buffer_load_dwordx4 v[124:127], v2, s[64:67], s10 offen offset:1024 sc1
  buffer_load_dwordx4 v[128:131], v2, s[64:67], s10 offen offset:2048 sc1
  buffer_load_dwordx4 v[132:135], v2, s[64:67], s10 offen offset:3072 sc1
  s_waitcnt vmcnt(0)
  v_mfma_f32_32x32x16_bf16 v[64:79], v[120:123], v[40:43], 0
  v_mfma_f32_32x32x16_bf16 v[64:79], v[124:127], v[44:47], v[64:79]
  s_nop 11
  v_max3_f32 v80, v64, v65, v66
  v_max3_f32 v81, v67, v68, v69
  v_max3_f32 v82, v70, v71, v72
  v_max3_f32 v83, v73, v74, v75
  v_max3_f32 v80, v80, v76, v77
  v_max3_f32 v81, v81, v78, v79
  v_max3_f32 v80, v80, v81, v82
  v_max_f32 v80, v80, v83
  v_mov_b32 v81, v80
  s_nop 1
  v_permlane32_swap_b32 v80, v81
  s_nop 0
  v_max_f32 v80, v80, v81
  v_max_f32 v80, v80, v90
  v_sub_f32 v81, v90, v80
  v_exp_f32 v81, v81
  v_mov_b32 v90, v80
  v_sub_f32 v64, v64, v80
  v_sub_f32 v65, v65, v80
  v_sub_f32 v66, v66, v80
  v_sub_f32 v67, v67, v80
  v_sub_f32 v68, v68, v80
  v_sub_f32 v69, v69, v80
  v_sub_f32 v70, v70, v80
  v_sub_f32 v71, v71, v80
  v_sub_f32 v72, v72, v80
  v_sub_f32 v73, v73, v80
  v_sub_f32 v74, v74, v80
  v_sub_f32 v75, v75, v80
  v_sub_f32 v76, v76, v80
  v_sub_f32 v77, v77, v80
  v_sub_f32 v78, v78, v80
  v_sub_f32 v79, v79, v80
  v_exp_f32 v64, v64
  v_exp_f32 v65, v65
  v_exp_f32 v66, v66
  v_exp_f32 v67, v67
  v_exp_f32 v68, v68
  v_exp_f32 v69, v69
  v_exp_f32 v70, v70
  v_exp_f32 v71, v71
  v_exp_f32 v72, v72
  v_exp_f32 v73, v73
  v_exp_f32 v74, v74
  v_exp_f32 v75, v75
  v_exp_f32 v76, v76
  v_exp_f32 v77, v77
  v_exp_f32 v78, v78
  v_exp_f32 v79, v79
  v_mul_f32 v96, v81, v96
  v_mul_f32 v97, v81, v97
  v_mul_f32 v98, v81, v98
  v_mul_f32 v99, v81, v99
  v_mul_f32 v100, v81, v100
  v_mul_f32 v101, v81, v101
  v_mul_f32 v102, v81, v102
  v_mul_f32 v103, v81, v103
  v_mul_f32 v104, v81, v104
  v_mul_f32 v105, v81, v105
  v_mul_f32 v106, v81, v106
  v_mul_f32 v107, v81, v107
  v_mul_f32 v108, v81, v108
  v_mul_f32 v109, v81, v109
  v_mul_f32 v110, v81, v110
  v_mul_f32 v111, v81, v111
  v_cvt_pk_bf16_f32 v112, v64, v65
  v_cvt_pk_bf16_f32 v113, v66, v67
  v_cvt_pk_bf16_f32 v114, v68, v69
  v_cvt_pk_bf16_f32 v115, v70, v71
  v_cvt_pk_bf16_f32 v116, v72, v73
  v_cvt_pk_bf16_f32 v117, v74, v75
  v_cvt_pk_bf16_f32 v118, v76, v77
  v_cvt_pk_bf16_f32 v119, v78, v79
  s_nop 1
  v_mfma_f32_32x32x16_bf16 v[96:111], v[128:131], v[112:115], v[96:111]
  v_mfma_f32_32x32x16_bf16 v[96:111], v[132:135], v[116:119], v[96:111]
  s_nop 11
  s_add_u32 s10, s10, 4096
  s_add_u32 s11, s11, 1
  s_cmp_lt_u32 s11, 64
  s_cbranch_scc1 L_slow_loop
  s_branch L_slow_ret
L_exit:
  s_endpgm
L_code_end:
.set CODE_BYTES, L_code_end - gated_mix__grouped_kv_mqa__dense_activation_gelu__prompt_kernel
.section .rodata,"a"
.p2align 6
.amdhsa_kernel gated_mix__grouped_kv_mqa__dense_activation_gelu__prompt_kernel
.amdhsa_next_free_vgpr 256
.amdhsa_next_free_sgpr 102
.amdhsa_accum_offset 256
.amdhsa_group_segment_fixed_size 0
.amdhsa_kernarg_size 112
.amdhsa_user_sgpr_count 2
.amdhsa_user_sgpr_kernarg_segment_ptr 1
.amdhsa_system_sgpr_workgroup_id_x 1
.amdhsa_float_denorm_mode_32 3
.end_amdhsa_kernel
```
